```python
import torch

def _softmax(x, axis=-1):
    return torch.softmax(x, dim=axis)
def _gelu(x):
    return torch.nn.functional.gelu(x, approximate="tanh")
def _silu(x):
    return torch.nn.functional.silu(x)
def _sigmoid(x):
    return torch.sigmoid(x)
def _layernorm(x, axis=-1, eps=1e-5):
    m = x.mean(dim=axis, keepdim=True)
    v = x.var(dim=axis, keepdim=True, unbiased=False)
    return (x - m) / torch.sqrt(v + eps)
def _scatter_add(tgt, idx, src, axis=0):
    return tgt.clone().index_add_(axis, idx, src)
def _segment_sum(src, seg, n):
    out = torch.zeros((n,) + src.shape[1:], dtype=src.dtype)
    return out.index_add_(0, seg, src)
def _pad(x, pw):
    flat = tuple(v for pair in reversed(pw) for v in pair)
    return torch.nn.functional.pad(x, flat)

kernel_name = 'sequential_preLN__sliding_block_cached__mixer_token_mlp__decode'

def setup_inputs():

    _w = (lambda a: (lambda t: t.to(torch.bfloat16) if t.is_floating_point() else t)(torch.as_tensor(a)))
    def _A_setup():
        B, Sq, D = 1, 1, 640
        Hq, Hkv, Sk, Dh = 32, 32, 16384, 192
        assert Hq % Hkv == 0, (Hq, Hkv)
        return {
            "x": _w((lambda *s: torch.randn(*s, dtype=torch.bfloat16) * 0.2)(B, Sq, D)),
            "k_cache": _w((lambda *s: torch.randn(*s, dtype=torch.bfloat16) * 1.6)(B, Hkv, Sk, Dh)),
            "v_cache": _w((lambda *s: torch.randn(*s, dtype=torch.bfloat16) * 3.2)(B, Hkv, Sk, Dh)),
            "wq": _w((lambda *s: torch.randn(*s, dtype=torch.bfloat16) * 1.6)(D, Hq * Dh) * (D ** -0.5)),
            "wo": _w((lambda *s: torch.randn(*s, dtype=torch.bfloat16) * 3.2)(Hq * Dh, D) * ((Hq * Dh) ** -0.5)),
        }
    _A_in = _A_setup()

    def _B_setup():
        B, S, D, F = 1, 1, 640, 1536
        return {
            "x": _w((lambda *s: torch.randn(*s, dtype=torch.bfloat16) * 0.2)(B, S, D)),
            "w1": _w((lambda *s: torch.randn(*s, dtype=torch.bfloat16) * 3.2)(S, F) * (S ** -0.5)),
            "b1": _w((lambda *s: torch.randn(*s, dtype=torch.bfloat16) * 3.2)(F) * 0.02),
            "w2": _w((lambda *s: torch.randn(*s, dtype=torch.bfloat16) * 3.2)(F, S) * (F ** -0.5)),
            "b2": _w((lambda *s: torch.randn(*s, dtype=torch.bfloat16) * 3.2)(S) * 0.02),
        }
    _B_in = _B_setup()

    return {
        "A_x": _A_in["x"],
        "A_k_cache": _A_in["k_cache"],
        "A_v_cache": _A_in["v_cache"],
        "A_wq": _A_in["wq"],
        "A_wo": _A_in["wo"],
        "B_x": _B_in["x"],
        "B_w1": _B_in["w1"],
        "B_b1": _B_in["b1"],
        "B_w2": _B_in["w2"],
        "B_b2": _B_in["b2"],
    }

def reference(A_x, A_k_cache, A_v_cache, A_wq, A_wo, B_x, B_w1, B_b1, B_w2, B_b2):
    def _A_ref(x, k_cache, v_cache, wq, wo):
        B, Sq, D = x.shape
        Hq, Dh = 32, 192
        Hkv, Sk = k_cache.shape[1], k_cache.shape[2]
        W = min(4096, max(256, Sk // 4))
        rep = Hq // Hkv
        q = (lambda x, *d: x.permute(*d))((x @ wq).reshape(B, Sq, Hq, Dh), 0, 2, 1, 3)
        k = (lambda x, n, axis: torch.repeat_interleave(x, n, dim=axis))(k_cache[:, :, Sk - W:, :], rep, axis=1)
        v = (lambda x, n, axis: torch.repeat_interleave(x, n, dim=axis))(v_cache[:, :, Sk - W:, :], rep, axis=1)
        scores = torch.einsum("bhqd,bhkd->bhqk", q, k) * (Dh ** -0.5)
        p = _softmax(scores, axis=-1)
        o = torch.einsum("bhqk,bhkd->bhqd", p, v)
        return (lambda x, *d: x.permute(*d))(o, 0, 2, 1, 3).reshape(B, Sq, Hq * Dh) @ wo

    def _B_ref(x, w1, b1, w2, b2):
        B, S, D = x.shape
        h = _layernorm(x, axis=-1)
        u = torch.einsum("bsd,sf->bdf", h, w1) + b1
        u = _gelu(u)
        y = torch.einsum("bdf,fs->bds", u, w2) + b2
        return (lambda x, *d: x.permute(*d))(y, 0, 2, 1)

    x = A_x
    h = x + _A_ref(_layernorm(x, axis=-1), A_k_cache, A_v_cache, A_wq, A_wo)
    h2 = h + _B_ref(_layernorm(h, axis=-1), B_w1, B_b1, B_w2, B_b2)
    return h2
```

```asm
; @launch grid=(256,1,1) block=(512,1,1) lds=19456
.amdgcn_target "amdgcn-amd-amdhsa--gfx950"
.text
.globl sequential_preLN__sliding_block_cached__mixer_token_mlp__decode_kernel
.p2align 8
.type sequential_preLN__sliding_block_cached__mixer_token_mlp__decode_kernel,@function
sequential_preLN__sliding_block_cached__mixer_token_mlp__decode_kernel:
s_cmp_ge_u32 s2, 256
s_cbranch_scc1 L_end
s_load_dwordx16 s[4:19], s[0:1], 0
s_load_dwordx8 s[20:27], s[0:1], 64
s_load_dwordx2 s[28:29], s[0:1], 96
v_lshrrev_b32 v3, 6, v0
v_and_b32 v1, 63, v0
s_and_b32 s30, s2, 7
v_readfirstlane_b32 s3, v3
s_lshl_b32 s30, s30, 2
s_bfe_u32 s31, s2, 0x20003
s_add_u32 s30, s30, s31
s_lshr_b32 s31, s2, 5
s_xor_b32 s3, s3, 4
s_and_b32 s32, s3, 3
s_lshl_b32 s33, s31, 2
s_add_u32 s35, s33, s32
s_mul_i32 s33, s35, 49152
s_mul_i32 s34, s30, 6291456
s_add_u32 s33, s33, s34
s_add_u32 s33, s33, 4718592
v_lshrrev_b32 v5, 3, v1
v_and_b32 v6, 7, v1
v_mul_u32_u24 v2, 384, v5
v_lshl_add_u32 v2, v6, 4, v2
s_cmp_ge_u32 s3, 4
s_waitcnt lgkmcnt(0)
s_cselect_b32 s6, s8, s6
s_cselect_b32 s7, s9, s7
s_load_dword s52, s[28:29], 196608
s_add_u32 s36, s6, s33
s_addc_u32 s37, s7, 0
s_mov_b32 s38, 49152
s_mov_b32 s39, 0x20000
s_mov_b32 s48, s4
s_mov_b32 s49, s5
s_mov_b32 s50, 1280
s_mov_b32 s51, 0x20000
s_mov_b32 s44, s28
s_mov_b32 s45, s29
s_mov_b32 s46, 1310720
s_mov_b32 s47, 0x20000
s_cmp_ge_u32 s3, 4
s_cbranch_scc1 L_V
s_mov_b32 s33, 0
buffer_load_dwordx4 v[64:67], v2, s[36:39], s33 offen offset:0 nt
buffer_load_dwordx4 v[68:71], v2, s[36:39], s33 offen offset:128 nt
buffer_load_dwordx4 v[72:75], v2, s[36:39], s33 offen offset:256 nt
s_mov_b32 s33, 3072
buffer_load_dwordx4 v[76:79], v2, s[36:39], s33 offen offset:0 nt
buffer_load_dwordx4 v[80:83], v2, s[36:39], s33 offen offset:128 nt
buffer_load_dwordx4 v[84:87], v2, s[36:39], s33 offen offset:256 nt
s_mov_b32 s33, 6144
buffer_load_dwordx4 v[88:91], v2, s[36:39], s33 offen offset:0 nt
buffer_load_dwordx4 v[92:95], v2, s[36:39], s33 offen offset:128 nt
buffer_load_dwordx4 v[96:99], v2, s[36:39], s33 offen offset:256 nt
s_mov_b32 s33, 9216
buffer_load_dwordx4 v[100:103], v2, s[36:39], s33 offen offset:0 nt
buffer_load_dwordx4 v[104:107], v2, s[36:39], s33 offen offset:128 nt
buffer_load_dwordx4 v[108:111], v2, s[36:39], s33 offen offset:256 nt
s_mov_b32 s33, 12288
buffer_load_dwordx4 v[112:115], v2, s[36:39], s33 offen offset:0 nt
buffer_load_dwordx4 v[116:119], v2, s[36:39], s33 offen offset:128 nt
buffer_load_dwordx4 v[120:123], v2, s[36:39], s33 offen offset:256 nt
s_mov_b32 s33, 15360
buffer_load_dwordx4 v[124:127], v2, s[36:39], s33 offen offset:0 nt
buffer_load_dwordx4 v[128:131], v2, s[36:39], s33 offen offset:128 nt
buffer_load_dwordx4 v[132:135], v2, s[36:39], s33 offen offset:256 nt
s_mov_b32 s33, 18432
buffer_load_dwordx4 v[136:139], v2, s[36:39], s33 offen offset:0 nt
buffer_load_dwordx4 v[140:143], v2, s[36:39], s33 offen offset:128 nt
buffer_load_dwordx4 v[144:147], v2, s[36:39], s33 offen offset:256 nt
s_mov_b32 s33, 21504
buffer_load_dwordx4 v[148:151], v2, s[36:39], s33 offen offset:0 nt
buffer_load_dwordx4 v[152:155], v2, s[36:39], s33 offen offset:128 nt
buffer_load_dwordx4 v[156:159], v2, s[36:39], s33 offen offset:256 nt
s_mov_b32 s33, 24576
buffer_load_dwordx4 v[160:163], v2, s[36:39], s33 offen offset:0 nt
buffer_load_dwordx4 v[164:167], v2, s[36:39], s33 offen offset:128 nt
buffer_load_dwordx4 v[168:171], v2, s[36:39], s33 offen offset:256 nt
s_mov_b32 s33, 27648
buffer_load_dwordx4 v[172:175], v2, s[36:39], s33 offen offset:0 nt
buffer_load_dwordx4 v[176:179], v2, s[36:39], s33 offen offset:128 nt
buffer_load_dwordx4 v[180:183], v2, s[36:39], s33 offen offset:256 nt
s_mov_b32 s33, 30720
buffer_load_dwordx4 v[184:187], v2, s[36:39], s33 offen offset:0 nt
buffer_load_dwordx4 v[188:191], v2, s[36:39], s33 offen offset:128 nt
buffer_load_dwordx4 v[192:195], v2, s[36:39], s33 offen offset:256 nt
s_mov_b32 s33, 33792
buffer_load_dwordx4 v[196:199], v2, s[36:39], s33 offen offset:0 nt
buffer_load_dwordx4 v[200:203], v2, s[36:39], s33 offen offset:128 nt
buffer_load_dwordx4 v[204:207], v2, s[36:39], s33 offen offset:256 nt
s_mov_b32 s33, 36864
buffer_load_dwordx4 v[208:211], v2, s[36:39], s33 offen offset:0 nt
buffer_load_dwordx4 v[212:215], v2, s[36:39], s33 offen offset:128 nt
buffer_load_dwordx4 v[216:219], v2, s[36:39], s33 offen offset:256 nt
s_mov_b32 s33, 39936
buffer_load_dwordx4 v[220:223], v2, s[36:39], s33 offen offset:0 nt
buffer_load_dwordx4 v[224:227], v2, s[36:39], s33 offen offset:128 nt
buffer_load_dwordx4 v[228:231], v2, s[36:39], s33 offen offset:256 nt
s_mov_b32 s33, 43008
buffer_load_dwordx4 v[232:235], v2, s[36:39], s33 offen offset:0 nt
buffer_load_dwordx4 v[236:239], v2, s[36:39], s33 offen offset:128 nt
buffer_load_dwordx4 v[240:243], v2, s[36:39], s33 offen offset:256 nt
s_mov_b32 s33, 46080
buffer_load_dwordx4 v[244:247], v2, s[36:39], s33 offen offset:0 nt
buffer_load_dwordx4 v[248:251], v2, s[36:39], s33 offen offset:128 nt
buffer_load_dwordx4 v[252:255], v2, s[36:39], s33 offen offset:256 nt
s_mov_b32 s63, 0xffff
v_and_b32 v7, 1, v1
v_lshlrev_b32 v7, 4, v7
v_lshlrev_b32 v7, v7, s63
v_bfe_u32 v3, v1, 1, 2
v_cmp_eq_u32 vcc, 0, v3
s_nop 1
v_cndmask_b32 v8, 0, v7, vcc
v_cmp_eq_u32 vcc, 1, v3
s_nop 1
v_cndmask_b32 v9, 0, v7, vcc
v_cmp_eq_u32 vcc, 2, v3
s_nop 1
v_cndmask_b32 v10, 0, v7, vcc
v_cmp_eq_u32 vcc, 3, v3
s_nop 1
v_cndmask_b32 v11, 0, v7, vcc
v_lshrrev_b32 v3, 5, v1
v_mul_u32_u24 v4, 768, v3
v_bfe_u32 v3, v1, 4, 1
v_lshl_add_u32 v4, v3, 7, v4
v_lshl_add_u32 v4, v6, 4, v4
s_mul_i32 s34, s32, 1536
v_add_u32 v4, s34, v4
s_waitcnt lgkmcnt(0)
s_add_u32 s52, s52, 1
s_and_b32 s53, s52, 0xff
s_and_b32 s54, s52, 0xffff
s_barrier
v_and_b32 v3, 7, v1
v_lshlrev_b32 v3, 4, v3
ds_read_b128 v[28:31], v3 offset:6144
ds_read_b128 v[32:35], v3 offset:6272
ds_read_b128 v[36:39], v3 offset:6400
v_mov_b32 v5, 0x3dd53b95
s_waitcnt lgkmcnt(0)
s_waitcnt vmcnt(20)
v_dot2_f32_bf16 v40, v64, v28, 0
v_dot2_f32_bf16 v41, v76, v28, 0
v_dot2_f32_bf16 v42, v88, v28, 0
v_dot2_f32_bf16 v43, v100, v28, 0
v_dot2_f32_bf16 v40, v65, v29, v40
v_dot2_f32_bf16 v41, v77, v29, v41
v_dot2_f32_bf16 v42, v89, v29, v42
v_dot2_f32_bf16 v43, v101, v29, v43
v_dot2_f32_bf16 v40, v66, v30, v40
v_dot2_f32_bf16 v41, v78, v30, v41
v_dot2_f32_bf16 v42, v90, v30, v42
v_dot2_f32_bf16 v43, v102, v30, v43
v_dot2_f32_bf16 v40, v67, v31, v40
v_dot2_f32_bf16 v41, v79, v31, v41
v_dot2_f32_bf16 v42, v91, v31, v42
v_dot2_f32_bf16 v43, v103, v31, v43
v_dot2_f32_bf16 v40, v68, v32, v40
v_dot2_f32_bf16 v41, v80, v32, v41
v_dot2_f32_bf16 v42, v92, v32, v42
v_dot2_f32_bf16 v43, v104, v32, v43
v_dot2_f32_bf16 v40, v69, v33, v40
v_dot2_f32_bf16 v41, v81, v33, v41
v_dot2_f32_bf16 v42, v93, v33, v42
v_dot2_f32_bf16 v43, v105, v33, v43
v_dot2_f32_bf16 v40, v70, v34, v40
v_dot2_f32_bf16 v41, v82, v34, v41
v_dot2_f32_bf16 v42, v94, v34, v42
v_dot2_f32_bf16 v43, v106, v34, v43
v_dot2_f32_bf16 v40, v71, v35, v40
v_dot2_f32_bf16 v41, v83, v35, v41
v_dot2_f32_bf16 v42, v95, v35, v42
v_dot2_f32_bf16 v43, v107, v35, v43
v_dot2_f32_bf16 v40, v72, v36, v40
v_dot2_f32_bf16 v41, v84, v36, v41
v_dot2_f32_bf16 v42, v96, v36, v42
v_dot2_f32_bf16 v43, v108, v36, v43
v_dot2_f32_bf16 v40, v73, v37, v40
v_dot2_f32_bf16 v41, v85, v37, v41
v_dot2_f32_bf16 v42, v97, v37, v42
v_dot2_f32_bf16 v43, v109, v37, v43
v_dot2_f32_bf16 v40, v74, v38, v40
v_dot2_f32_bf16 v41, v86, v38, v41
v_dot2_f32_bf16 v42, v98, v38, v42
v_dot2_f32_bf16 v43, v110, v38, v43
v_dot2_f32_bf16 v40, v75, v39, v40
v_dot2_f32_bf16 v41, v87, v39, v41
v_dot2_f32_bf16 v42, v99, v39, v42
v_dot2_f32_bf16 v43, v111, v39, v43
s_nop 2
v_add_f32_dpp v40, v40, v40 quad_perm:[1,0,3,2] row_mask:0xf bank_mask:0xf
v_add_f32_dpp v41, v41, v41 quad_perm:[1,0,3,2] row_mask:0xf bank_mask:0xf
v_add_f32_dpp v42, v42, v42 quad_perm:[1,0,3,2] row_mask:0xf bank_mask:0xf
v_add_f32_dpp v43, v43, v43 quad_perm:[1,0,3,2] row_mask:0xf bank_mask:0xf
v_add_f32_dpp v40, v40, v40 quad_perm:[2,3,0,1] row_mask:0xf bank_mask:0xf
v_add_f32_dpp v41, v41, v41 quad_perm:[2,3,0,1] row_mask:0xf bank_mask:0xf
v_add_f32_dpp v42, v42, v42 quad_perm:[2,3,0,1] row_mask:0xf bank_mask:0xf
v_add_f32_dpp v43, v43, v43 quad_perm:[2,3,0,1] row_mask:0xf bank_mask:0xf
v_add_f32_dpp v40, v40, v40 row_half_mirror row_mask:0xf bank_mask:0xf
v_add_f32_dpp v41, v41, v41 row_half_mirror row_mask:0xf bank_mask:0xf
v_add_f32_dpp v42, v42, v42 row_half_mirror row_mask:0xf bank_mask:0xf
v_add_f32_dpp v43, v43, v43 row_half_mirror row_mask:0xf bank_mask:0xf
s_waitcnt vmcnt(20)
v_dot2_f32_bf16 v44, v112, v28, 0
v_dot2_f32_bf16 v45, v124, v28, 0
v_dot2_f32_bf16 v46, v136, v28, 0
v_dot2_f32_bf16 v47, v148, v28, 0
v_dot2_f32_bf16 v44, v113, v29, v44
v_dot2_f32_bf16 v45, v125, v29, v45
v_dot2_f32_bf16 v46, v137, v29, v46
v_dot2_f32_bf16 v47, v149, v29, v47
v_dot2_f32_bf16 v44, v114, v30, v44
v_dot2_f32_bf16 v45, v126, v30, v45
v_dot2_f32_bf16 v46, v138, v30, v46
v_dot2_f32_bf16 v47, v150, v30, v47
v_dot2_f32_bf16 v44, v115, v31, v44
v_dot2_f32_bf16 v45, v127, v31, v45
v_dot2_f32_bf16 v46, v139, v31, v46
v_dot2_f32_bf16 v47, v151, v31, v47
v_dot2_f32_bf16 v44, v116, v32, v44
v_dot2_f32_bf16 v45, v128, v32, v45
v_dot2_f32_bf16 v46, v140, v32, v46
v_dot2_f32_bf16 v47, v152, v32, v47
v_dot2_f32_bf16 v44, v117, v33, v44
v_dot2_f32_bf16 v45, v129, v33, v45
v_dot2_f32_bf16 v46, v141, v33, v46
v_dot2_f32_bf16 v47, v153, v33, v47
v_dot2_f32_bf16 v44, v118, v34, v44
v_dot2_f32_bf16 v45, v130, v34, v45
v_dot2_f32_bf16 v46, v142, v34, v46
v_dot2_f32_bf16 v47, v154, v34, v47
v_dot2_f32_bf16 v44, v119, v35, v44
v_dot2_f32_bf16 v45, v131, v35, v45
v_dot2_f32_bf16 v46, v143, v35, v46
v_dot2_f32_bf16 v47, v155, v35, v47
v_dot2_f32_bf16 v44, v120, v36, v44
v_dot2_f32_bf16 v45, v132, v36, v45
v_dot2_f32_bf16 v46, v144, v36, v46
v_dot2_f32_bf16 v47, v156, v36, v47
v_dot2_f32_bf16 v44, v121, v37, v44
v_dot2_f32_bf16 v45, v133, v37, v45
v_dot2_f32_bf16 v46, v145, v37, v46
v_dot2_f32_bf16 v47, v157, v37, v47
v_dot2_f32_bf16 v44, v122, v38, v44
v_dot2_f32_bf16 v45, v134, v38, v45
v_dot2_f32_bf16 v46, v146, v38, v46
v_dot2_f32_bf16 v47, v158, v38, v47
v_dot2_f32_bf16 v44, v123, v39, v44
v_dot2_f32_bf16 v45, v135, v39, v45
v_dot2_f32_bf16 v46, v147, v39, v46
v_dot2_f32_bf16 v47, v159, v39, v47
s_nop 2
v_add_f32_dpp v44, v44, v44 quad_perm:[1,0,3,2] row_mask:0xf bank_mask:0xf
v_add_f32_dpp v45, v45, v45 quad_perm:[1,0,3,2] row_mask:0xf bank_mask:0xf
v_add_f32_dpp v46, v46, v46 quad_perm:[1,0,3,2] row_mask:0xf bank_mask:0xf
v_add_f32_dpp v47, v47, v47 quad_perm:[1,0,3,2] row_mask:0xf bank_mask:0xf
v_add_f32_dpp v44, v44, v44 quad_perm:[2,3,0,1] row_mask:0xf bank_mask:0xf
v_add_f32_dpp v45, v45, v45 quad_perm:[2,3,0,1] row_mask:0xf bank_mask:0xf
v_add_f32_dpp v46, v46, v46 quad_perm:[2,3,0,1] row_mask:0xf bank_mask:0xf
v_add_f32_dpp v47, v47, v47 quad_perm:[2,3,0,1] row_mask:0xf bank_mask:0xf
v_add_f32_dpp v44, v44, v44 row_half_mirror row_mask:0xf bank_mask:0xf
v_add_f32_dpp v45, v45, v45 row_half_mirror row_mask:0xf bank_mask:0xf
v_add_f32_dpp v46, v46, v46 row_half_mirror row_mask:0xf bank_mask:0xf
v_add_f32_dpp v47, v47, v47 row_half_mirror row_mask:0xf bank_mask:0xf
s_waitcnt vmcnt(12)
v_dot2_f32_bf16 v48, v160, v28, 0
v_dot2_f32_bf16 v49, v172, v28, 0
v_dot2_f32_bf16 v50, v184, v28, 0
v_dot2_f32_bf16 v51, v196, v28, 0
v_dot2_f32_bf16 v48, v161, v29, v48
v_dot2_f32_bf16 v49, v173, v29, v49
v_dot2_f32_bf16 v50, v185, v29, v50
v_dot2_f32_bf16 v51, v197, v29, v51
v_dot2_f32_bf16 v48, v162, v30, v48
v_dot2_f32_bf16 v49, v174, v30, v49
v_dot2_f32_bf16 v50, v186, v30, v50
v_dot2_f32_bf16 v51, v198, v30, v51
v_dot2_f32_bf16 v48, v163, v31, v48
v_dot2_f32_bf16 v49, v175, v31, v49
v_dot2_f32_bf16 v50, v187, v31, v50
v_dot2_f32_bf16 v51, v199, v31, v51
v_dot2_f32_bf16 v48, v164, v32, v48
v_dot2_f32_bf16 v49, v176, v32, v49
v_dot2_f32_bf16 v50, v188, v32, v50
v_dot2_f32_bf16 v51, v200, v32, v51
v_dot2_f32_bf16 v48, v165, v33, v48
v_dot2_f32_bf16 v49, v177, v33, v49
v_dot2_f32_bf16 v50, v189, v33, v50
v_dot2_f32_bf16 v51, v201, v33, v51
v_dot2_f32_bf16 v48, v166, v34, v48
v_dot2_f32_bf16 v49, v178, v34, v49
v_dot2_f32_bf16 v50, v190, v34, v50
v_dot2_f32_bf16 v51, v202, v34, v51
v_dot2_f32_bf16 v48, v167, v35, v48
v_dot2_f32_bf16 v49, v179, v35, v49
v_dot2_f32_bf16 v50, v191, v35, v50
v_dot2_f32_bf16 v51, v203, v35, v51
v_dot2_f32_bf16 v48, v168, v36, v48
v_dot2_f32_bf16 v49, v180, v36, v49
v_dot2_f32_bf16 v50, v192, v36, v50
v_dot2_f32_bf16 v51, v204, v36, v51
v_dot2_f32_bf16 v48, v169, v37, v48
v_dot2_f32_bf16 v49, v181, v37, v49
v_dot2_f32_bf16 v50, v193, v37, v50
v_dot2_f32_bf16 v51, v205, v37, v51
v_dot2_f32_bf16 v48, v170, v38, v48
v_dot2_f32_bf16 v49, v182, v38, v49
v_dot2_f32_bf16 v50, v194, v38, v50
v_dot2_f32_bf16 v51, v206, v38, v51
v_dot2_f32_bf16 v48, v171, v39, v48
v_dot2_f32_bf16 v49, v183, v39, v49
v_dot2_f32_bf16 v50, v195, v39, v50
v_dot2_f32_bf16 v51, v207, v39, v51
s_nop 2
v_add_f32_dpp v48, v48, v48 quad_perm:[1,0,3,2] row_mask:0xf bank_mask:0xf
v_add_f32_dpp v49, v49, v49 quad_perm:[1,0,3,2] row_mask:0xf bank_mask:0xf
v_add_f32_dpp v50, v50, v50 quad_perm:[1,0,3,2] row_mask:0xf bank_mask:0xf
v_add_f32_dpp v51, v51, v51 quad_perm:[1,0,3,2] row_mask:0xf bank_mask:0xf
v_add_f32_dpp v48, v48, v48 quad_perm:[2,3,0,1] row_mask:0xf bank_mask:0xf
v_add_f32_dpp v49, v49, v49 quad_perm:[2,3,0,1] row_mask:0xf bank_mask:0xf
v_add_f32_dpp v50, v50, v50 quad_perm:[2,3,0,1] row_mask:0xf bank_mask:0xf
v_add_f32_dpp v51, v51, v51 quad_perm:[2,3,0,1] row_mask:0xf bank_mask:0xf
v_add_f32_dpp v48, v48, v48 row_half_mirror row_mask:0xf bank_mask:0xf
v_add_f32_dpp v49, v49, v49 row_half_mirror row_mask:0xf bank_mask:0xf
v_add_f32_dpp v50, v50, v50 row_half_mirror row_mask:0xf bank_mask:0xf
v_add_f32_dpp v51, v51, v51 row_half_mirror row_mask:0xf bank_mask:0xf
s_waitcnt vmcnt(0)
v_dot2_f32_bf16 v52, v208, v28, 0
v_dot2_f32_bf16 v53, v220, v28, 0
v_dot2_f32_bf16 v54, v232, v28, 0
v_dot2_f32_bf16 v55, v244, v28, 0
v_dot2_f32_bf16 v52, v209, v29, v52
v_dot2_f32_bf16 v53, v221, v29, v53
v_dot2_f32_bf16 v54, v233, v29, v54
v_dot2_f32_bf16 v55, v245, v29, v55
v_dot2_f32_bf16 v52, v210, v30, v52
v_dot2_f32_bf16 v53, v222, v30, v53
v_dot2_f32_bf16 v54, v234, v30, v54
v_dot2_f32_bf16 v55, v246, v30, v55
v_dot2_f32_bf16 v52, v211, v31, v52
v_dot2_f32_bf16 v53, v223, v31, v53
v_dot2_f32_bf16 v54, v235, v31, v54
v_dot2_f32_bf16 v55, v247, v31, v55
v_dot2_f32_bf16 v52, v212, v32, v52
v_dot2_f32_bf16 v53, v224, v32, v53
v_dot2_f32_bf16 v54, v236, v32, v54
v_dot2_f32_bf16 v55, v248, v32, v55
v_dot2_f32_bf16 v52, v213, v33, v52
v_dot2_f32_bf16 v53, v225, v33, v53
v_dot2_f32_bf16 v54, v237, v33, v54
v_dot2_f32_bf16 v55, v249, v33, v55
v_dot2_f32_bf16 v52, v214, v34, v52
v_dot2_f32_bf16 v53, v226, v34, v53
v_dot2_f32_bf16 v54, v238, v34, v54
v_dot2_f32_bf16 v55, v250, v34, v55
v_dot2_f32_bf16 v52, v215, v35, v52
v_dot2_f32_bf16 v53, v227, v35, v53
v_dot2_f32_bf16 v54, v239, v35, v54
v_dot2_f32_bf16 v55, v251, v35, v55
v_dot2_f32_bf16 v52, v216, v36, v52
v_dot2_f32_bf16 v53, v228, v36, v53
v_dot2_f32_bf16 v54, v240, v36, v54
v_dot2_f32_bf16 v55, v252, v36, v55
v_dot2_f32_bf16 v52, v217, v37, v52
v_dot2_f32_bf16 v53, v229, v37, v53
v_dot2_f32_bf16 v54, v241, v37, v54
v_dot2_f32_bf16 v55, v253, v37, v55
v_dot2_f32_bf16 v52, v218, v38, v52
v_dot2_f32_bf16 v53, v230, v38, v53
v_dot2_f32_bf16 v54, v242, v38, v54
v_dot2_f32_bf16 v55, v254, v38, v55
v_dot2_f32_bf16 v52, v219, v39, v52
v_dot2_f32_bf16 v53, v231, v39, v53
v_dot2_f32_bf16 v54, v243, v39, v54
v_dot2_f32_bf16 v55, v255, v39, v55
s_nop 2
v_add_f32_dpp v52, v52, v52 quad_perm:[1,0,3,2] row_mask:0xf bank_mask:0xf
v_add_f32_dpp v53, v53, v53 quad_perm:[1,0,3,2] row_mask:0xf bank_mask:0xf
v_add_f32_dpp v54, v54, v54 quad_perm:[1,0,3,2] row_mask:0xf bank_mask:0xf
v_add_f32_dpp v55, v55, v55 quad_perm:[1,0,3,2] row_mask:0xf bank_mask:0xf
v_add_f32_dpp v52, v52, v52 quad_perm:[2,3,0,1] row_mask:0xf bank_mask:0xf
v_add_f32_dpp v53, v53, v53 quad_perm:[2,3,0,1] row_mask:0xf bank_mask:0xf
v_add_f32_dpp v54, v54, v54 quad_perm:[2,3,0,1] row_mask:0xf bank_mask:0xf
v_add_f32_dpp v55, v55, v55 quad_perm:[2,3,0,1] row_mask:0xf bank_mask:0xf
v_add_f32_dpp v52, v52, v52 row_half_mirror row_mask:0xf bank_mask:0xf
v_add_f32_dpp v53, v53, v53 row_half_mirror row_mask:0xf bank_mask:0xf
v_add_f32_dpp v54, v54, v54 row_half_mirror row_mask:0xf bank_mask:0xf
v_add_f32_dpp v55, v55, v55 row_half_mirror row_mask:0xf bank_mask:0xf
v_max3_f32 v6, v40, v41, v42
v_max3_f32 v6, v6, v43, v44
v_max3_f32 v6, v6, v45, v46
v_max3_f32 v6, v6, v47, v48
v_max3_f32 v6, v6, v49, v50
v_max3_f32 v6, v6, v51, v52
v_max3_f32 v6, v6, v53, v54
v_max_f32 v6, v6, v55
s_nop 1
v_max_f32_dpp v6, v6, v6 row_ror:8 row_mask:0xf bank_mask:0xf
s_nop 1
v_max_f32_dpp v6, v6, v6 row_bcast:15 row_mask:0xa bank_mask:0xf
s_nop 1
v_max_f32_dpp v6, v6, v6 row_bcast:31 row_mask:0xc bank_mask:0xf
v_mul_f32 v6, v5, v6
s_nop 0
v_readlane_b32 s60, v6, 63
s_nop 1
v_fma_f32 v40, v40, v5, -s60
v_fma_f32 v41, v41, v5, -s60
v_fma_f32 v42, v42, v5, -s60
v_fma_f32 v43, v43, v5, -s60
v_fma_f32 v44, v44, v5, -s60
v_fma_f32 v45, v45, v5, -s60
v_fma_f32 v46, v46, v5, -s60
v_fma_f32 v47, v47, v5, -s60
v_fma_f32 v48, v48, v5, -s60
v_fma_f32 v49, v49, v5, -s60
v_fma_f32 v50, v50, v5, -s60
v_fma_f32 v51, v51, v5, -s60
v_fma_f32 v52, v52, v5, -s60
v_fma_f32 v53, v53, v5, -s60
v_fma_f32 v54, v54, v5, -s60
v_fma_f32 v55, v55, v5, -s60
v_exp_f32 v40, v40
v_exp_f32 v41, v41
v_exp_f32 v42, v42
v_exp_f32 v43, v43
v_exp_f32 v44, v44
v_exp_f32 v45, v45
v_exp_f32 v46, v46
v_exp_f32 v47, v47
v_exp_f32 v48, v48
v_exp_f32 v49, v49
v_exp_f32 v50, v50
v_exp_f32 v51, v51
v_exp_f32 v52, v52
v_exp_f32 v53, v53
v_exp_f32 v54, v54
v_exp_f32 v55, v55
v_add_f32 v7, v40, v41
v_add_f32 v7, v7, v42
v_add_f32 v7, v7, v43
v_add_f32 v7, v7, v44
v_add_f32 v7, v7, v45
v_add_f32 v7, v7, v46
v_add_f32 v7, v7, v47
v_add_f32 v7, v7, v48
v_add_f32 v7, v7, v49
v_add_f32 v7, v7, v50
v_add_f32 v7, v7, v51
v_add_f32 v7, v7, v52
v_add_f32 v7, v7, v53
v_add_f32 v7, v7, v54
v_add_f32 v7, v7, v55
v_cvt_pk_bf16_f32 v40, v40, v40
v_cvt_pk_bf16_f32 v41, v41, v41
v_cvt_pk_bf16_f32 v42, v42, v42
v_cvt_pk_bf16_f32 v43, v43, v43
v_cvt_pk_bf16_f32 v44, v44, v44
v_cvt_pk_bf16_f32 v45, v45, v45
v_cvt_pk_bf16_f32 v46, v46, v46
v_cvt_pk_bf16_f32 v47, v47, v47
v_cvt_pk_bf16_f32 v48, v48, v48
v_cvt_pk_bf16_f32 v49, v49, v49
v_cvt_pk_bf16_f32 v50, v50, v50
v_cvt_pk_bf16_f32 v51, v51, v51
v_cvt_pk_bf16_f32 v52, v52, v52
v_cvt_pk_bf16_f32 v53, v53, v53
v_cvt_pk_bf16_f32 v54, v54, v54
v_cvt_pk_bf16_f32 v55, v55, v55
v_lshlrev_b32 v3, 3, v1
s_lshl_b32 s34, s32, 9
v_add_u32 v3, s34, v3
s_mov_b32 exec_lo, 0x01010101
s_mov_b32 exec_hi, 0x01010101
ds_write_b128 v3, v[40:43] offset:6656
ds_write_b128 v3, v[44:47] offset:6672
ds_write_b128 v3, v[48:51] offset:6688
ds_write_b128 v3, v[52:55] offset:6704
s_mov_b64 exec, -1
s_nop 1
v_add_f32_dpp v7, v7, v7 row_ror:8 row_mask:0xf bank_mask:0xf
s_nop 1
v_add_f32_dpp v7, v7, v7 row_bcast:15 row_mask:0xa bank_mask:0xf
s_nop 1
v_add_f32_dpp v7, v7, v7 row_bcast:31 row_mask:0xc bank_mask:0xf
s_lshl_b32 s34, s32, 3
v_mov_b32 v3, s34
s_mov_b32 exec_lo, 0
s_mov_b32 exec_hi, 0x80000000
ds_write_b64 v3, v[6:7] offset:9024
s_mov_b64 exec, -1
v_mov_b32 v38, 0xff
s_waitcnt lgkmcnt(0)
s_barrier
s_cmp_eq_u32 s3, 0
s_cbranch_scc0 L_K1
ds_read_b128 v[40:43], v3 offset:9024
ds_read_b128 v[44:47], v3 offset:9040
v_mul_u32_u24 v3, 43, v1
v_lshrrev_b32 v3, 8, v3
v_mul_u32_u24 v30, 928, v3
v_lshl_add_u32 v30, v1, 4, v30
s_lshl_b32 s34, s30, 13
s_lshl_b32 s63, s31, 7
s_add_u32 s34, s34, s63
s_add_u32 s34, s34, 262144
v_add_u32 v30, s34, v30
s_sub_u32 s34, s34, 49056
v_lshl_add_u32 v3, v1, 10, s34
v_cmp_gt_u32 vcc, 48, v1
v_mov_b32 v18, s52
v_mov_b32 v19, s52
v_cndmask_b32 v30, v3, v30, vcc
s_waitcnt lgkmcnt(0)
v_max3_f32 v16, v40, v42, v44
v_max_f32 v16, v16, v46
v_sub_f32 v40, v40, v16
v_sub_f32 v42, v42, v16
v_sub_f32 v44, v44, v16
v_sub_f32 v46, v46, v16
v_exp_f32 v40, v40
v_exp_f32 v42, v42
v_exp_f32 v44, v44
v_exp_f32 v46, v46
v_mul_f32 v17, v40, v41
v_fma_f32 v17, v42, v43, v17
v_fma_f32 v17, v44, v45, v17
v_fma_f32 v17, v46, v47, v17
v_readfirstlane_b32 s56, v40
v_readfirstlane_b32 s57, v42
v_readfirstlane_b32 s58, v44
v_readfirstlane_b32 s59, v46
L_K1:
s_mul_i32 s34, s30, 245760
s_lshl_b32 s63, s32, 8
s_add_u32 s34, s34, s63
s_add_u32 s40, s12, s34
s_addc_u32 s41, s13, 0
s_mov_b32 s42, 244992
s_mov_b32 s43, 0x20000
s_sub_u32 s42, 245760, s63
s_mul_i32 s34, s31, 6
v_lshrrev_b32 v3, 4, v1
v_and_b32 v5, 15, v1
v_add_u32 v6, s34, v3
v_lshrrev_b32 v7, 3, v6
v_and_b32 v6, 7, v6
v_lshl_add_u32 v6, v7, 5, v6
v_mul_u32_u24 v32, 1280, v6
v_lshl_add_u32 v32, v5, 4, v32
v_lshrrev_b32 v6, 1, v3
s_add_u32 s34, s34, 4
v_add_u32 v6, s34, v6
v_lshrrev_b32 v7, 3, v6
v_and_b32 v6, 7, v6
v_lshl_add_u32 v6, v7, 5, v6
v_and_b32 v7, 1, v3
v_lshl_add_u32 v6, v7, 4, v6
v_mul_u32_u24 v33, 1280, v6
v_lshl_add_u32 v33, v5, 4, v33
v_and_b32 v6, 7, v1
v_lshlrev_b32 v7, 7, v6
v_lshl_add_u32 v34, v3, 4, v7
v_mov_b32 v31, v7
v_lshl_add_u32 v35, v3, 3, v7
v_lshrrev_b32 v7, 2, v6
v_lshl_add_u32 v7, v3, 1, v7
v_and_b32 v6, 3, v1
v_lshlrev_b32 v6, 4, v6
v_lshl_add_u32 v36, v7, 14, v6
s_lshl_b32 s34, s32, 17
s_lshl_b32 s63, s2, 6
s_add_u32 s34, s34, s63
s_add_u32 s34, s34, 524288
v_add_u32 v36, s34, v36
v_lshlrev_b32 v37, 4, v1
s_barrier
s_setprio 3
s_mov_b32 s33, 0
buffer_load_dwordx4 v[64:67], v32, s[40:43], s33 offen offset:0 nt
s_mov_b32 s33, 10240
buffer_load_dwordx4 v[68:71], v32, s[40:43], s33 offen offset:0 nt
s_mov_b32 s33, 20480
buffer_load_dwordx4 v[72:75], v32, s[40:43], s33 offen offset:0 nt
s_mov_b32 s33, 30720
buffer_load_dwordx4 v[76:79], v32, s[40:43], s33 offen offset:0 nt
s_mov_b32 s33, 0
buffer_load_dwordx4 v[80:83], v33, s[40:43], s33 offen offset:0 nt
s_mov_b32 s33, 10240
buffer_load_dwordx4 v[84:87], v33, s[40:43], s33 offen offset:0 nt
s_cmp_eq_u32 s3, 1
s_cbranch_scc0 L_K3
s_mov_b32 s33, 0
buffer_load_dwordx4 v[88:91], v32, s[40:43], s33 offen offset:768 nt
s_mov_b32 s33, 10240
buffer_load_dwordx4 v[92:95], v32, s[40:43], s33 offen offset:768 nt
s_mov_b32 s33, 20480
buffer_load_dwordx4 v[96:99], v32, s[40:43], s33 offen offset:768 nt
s_mov_b32 s33, 30720
buffer_load_dwordx4 v[100:103], v32, s[40:43], s33 offen offset:768 nt
s_mov_b32 s33, 0
buffer_load_dwordx4 v[104:107], v33, s[40:43], s33 offen offset:768 nt
s_mov_b32 s33, 10240
buffer_load_dwordx4 v[108:111], v33, s[40:43], s33 offen offset:768 nt
L_K3:
s_barrier
s_cmp_eq_u32 s3, 0
s_cbranch_scc0 L_K4w
s_mov_b32 exec_hi, 0xffff
ds_read_b128 v[112:115], v37 offset:0
ds_read_b128 v[116:119], v37 offset:768
ds_read_b128 v[120:123], v37 offset:1536
ds_read_b128 v[124:127], v37 offset:2304
ds_read_b128 v[128:131], v37 offset:3072
ds_read_b128 v[132:135], v37 offset:3840
ds_read_b128 v[136:139], v37 offset:4608
ds_read_b128 v[140:143], v37 offset:5376
s_waitcnt lgkmcnt(6)
v_pk_add_f32 v[112:113], v[112:113], v[116:117]
v_pk_add_f32 v[114:115], v[114:115], v[118:119]
v_pk_mul_f32 v[16:17], v[112:113], s[56:57] op_sel_hi:[1,0]
v_pk_mul_f32 v[18:19], v[114:115], s[56:57] op_sel_hi:[1,0]
s_waitcnt lgkmcnt(4)
v_pk_add_f32 v[120:121], v[120:121], v[124:125]
v_pk_add_f32 v[122:123], v[122:123], v[126:127]
v_pk_fma_f32 v[16:17], v[120:121], s[56:57], v[16:17] op_sel:[0,1,0] op_sel_hi:[1,1,1]
v_pk_fma_f32 v[18:19], v[122:123], s[56:57], v[18:19] op_sel:[0,1,0] op_sel_hi:[1,1,1]
s_waitcnt lgkmcnt(2)
v_pk_add_f32 v[128:129], v[128:129], v[132:133]
v_pk_add_f32 v[130:131], v[130:131], v[134:135]
v_pk_fma_f32 v[16:17], v[128:129], s[58:59], v[16:17] op_sel:[0,0,0] op_sel_hi:[1,0,1]
v_pk_fma_f32 v[18:19], v[130:131], s[58:59], v[18:19] op_sel:[0,0,0] op_sel_hi:[1,0,1]
s_waitcnt lgkmcnt(0)
v_pk_add_f32 v[136:137], v[136:137], v[140:141]
v_pk_add_f32 v[138:139], v[138:139], v[142:143]
v_pk_fma_f32 v[16:17], v[136:137], s[58:59], v[16:17] op_sel:[0,1,0] op_sel_hi:[1,1,1]
v_pk_fma_f32 v[18:19], v[138:139], s[58:59], v[18:19] op_sel:[0,1,0] op_sel_hi:[1,1,1]
v_bfi_b32 v16, v38, s52, v16
v_bfi_b32 v17, v38, s52, v17
v_bfi_b32 v18, v38, s52, v18
v_bfi_b32 v19, v38, s52, v19
s_mov_b32 exec_hi, 0xffffff
s_waitcnt vmcnt(0)
buffer_store_dwordx4 v[16:19], v30, s[44:47], 0 offen sc1
s_mov_b64 exec, -1
s_branch L_K4
L_K4w:
s_waitcnt vmcnt(0)
L_K4:
s_barrier
ds_read_b64 v[48:49], v31 offset:18528
ds_read_b128 v[40:43], v34 offset:18432
ds_read_b64 v[44:45], v35 offset:18496
s_waitcnt lgkmcnt(2)
v_max_f32_dpp v3, v48, v48 quad_perm:[1,0,3,2] row_mask:0xf bank_mask:0xf
s_nop 1
v_max_f32_dpp v3, v3, v3 quad_perm:[2,3,0,1] row_mask:0xf bank_mask:0xf
s_nop 1
v_max_f32_dpp v3, v3, v3 row_half_mirror row_mask:0xf bank_mask:0xf
v_sub_f32 v48, v48, v3
v_exp_f32 v48, v48
s_nop 0
v_mul_f32 v46, v48, v49
s_waitcnt lgkmcnt(0)
v_pk_mul_f32 v[40:41], v[40:41], v[48:49] op_sel_hi:[1,0]
v_pk_mul_f32 v[42:43], v[42:43], v[48:49] op_sel_hi:[1,0]
v_pk_mul_f32 v[44:45], v[44:45], v[48:49] op_sel_hi:[1,0]
v_add_f32_dpp v46, v46, v46 quad_perm:[1,0,3,2] row_mask:0xf bank_mask:0xf
v_add_f32_dpp v40, v40, v40 quad_perm:[1,0,3,2] row_mask:0xf bank_mask:0xf
v_add_f32_dpp v41, v41, v41 quad_perm:[1,0,3,2] row_mask:0xf bank_mask:0xf
v_add_f32_dpp v42, v42, v42 quad_perm:[1,0,3,2] row_mask:0xf bank_mask:0xf
v_add_f32_dpp v43, v43, v43 quad_perm:[1,0,3,2] row_mask:0xf bank_mask:0xf
v_add_f32_dpp v44, v44, v44 quad_perm:[1,0,3,2] row_mask:0xf bank_mask:0xf
v_add_f32_dpp v45, v45, v45 quad_perm:[1,0,3,2] row_mask:0xf bank_mask:0xf
v_add_f32_dpp v46, v46, v46 quad_perm:[2,3,0,1] row_mask:0xf bank_mask:0xf
v_add_f32_dpp v40, v40, v40 quad_perm:[2,3,0,1] row_mask:0xf bank_mask:0xf
v_add_f32_dpp v41, v41, v41 quad_perm:[2,3,0,1] row_mask:0xf bank_mask:0xf
v_add_f32_dpp v42, v42, v42 quad_perm:[2,3,0,1] row_mask:0xf bank_mask:0xf
v_add_f32_dpp v43, v43, v43 quad_perm:[2,3,0,1] row_mask:0xf bank_mask:0xf
v_add_f32_dpp v44, v44, v44 quad_perm:[2,3,0,1] row_mask:0xf bank_mask:0xf
v_add_f32_dpp v45, v45, v45 quad_perm:[2,3,0,1] row_mask:0xf bank_mask:0xf
v_add_f32_dpp v46, v46, v46 row_half_mirror row_mask:0xf bank_mask:0xf
v_add_f32_dpp v40, v40, v40 row_half_mirror row_mask:0xf bank_mask:0xf
v_rcp_f32 v46, v46
v_add_f32_dpp v41, v41, v41 row_half_mirror row_mask:0xf bank_mask:0xf
v_add_f32_dpp v42, v42, v42 row_half_mirror row_mask:0xf bank_mask:0xf
v_add_f32_dpp v43, v43, v43 row_half_mirror row_mask:0xf bank_mask:0xf
v_add_f32_dpp v44, v44, v44 row_half_mirror row_mask:0xf bank_mask:0xf
v_add_f32_dpp v45, v45, v45 row_half_mirror row_mask:0xf bank_mask:0xf
v_pk_mul_f32 v[40:41], v[40:41], v[46:47] op_sel_hi:[1,0]
v_pk_mul_f32 v[42:43], v[42:43], v[46:47] op_sel_hi:[1,0]
v_pk_mul_f32 v[44:45], v[44:45], v[46:47] op_sel_hi:[1,0]
v_cvt_pk_bf16_f32 v40, v40, v40
v_cvt_pk_bf16_f32 v41, v41, v41
v_cvt_pk_bf16_f32 v42, v42, v42
v_cvt_pk_bf16_f32 v43, v43, v43
v_cvt_pk_bf16_f32 v44, v44, v44
v_cvt_pk_bf16_f32 v45, v45, v45
v_and_b32 v112, v8, v40
v_and_b32 v113, v9, v40
v_and_b32 v114, v10, v40
v_and_b32 v115, v11, v40
v_and_b32 v116, v8, v41
v_and_b32 v117, v9, v41
v_and_b32 v118, v10, v41
v_and_b32 v119, v11, v41
v_mfma_f32_16x16x32_bf16 v[16:19], v[64:67], v[112:115], 0
v_and_b32 v120, v8, v42
v_and_b32 v121, v9, v42
v_and_b32 v122, v10, v42
v_and_b32 v123, v11, v42
v_mfma_f32_16x16x32_bf16 v[16:19], v[68:71], v[116:119], v[16:19]
v_and_b32 v124, v8, v43
v_and_b32 v125, v9, v43
v_and_b32 v126, v10, v43
v_and_b32 v127, v11, v43
v_mfma_f32_16x16x32_bf16 v[16:19], v[72:75], v[120:123], v[16:19]
v_and_b32 v128, v8, v44
v_and_b32 v129, v9, v44
v_and_b32 v130, v10, v44
v_and_b32 v131, v11, v44
v_mfma_f32_16x16x32_bf16 v[16:19], v[76:79], v[124:127], v[16:19]
v_and_b32 v132, v8, v45
v_and_b32 v133, v9, v45
v_and_b32 v134, v10, v45
v_and_b32 v135, v11, v45
v_mfma_f32_16x16x32_bf16 v[16:19], v[80:83], v[128:131], v[16:19]
s_nop 1
v_mfma_f32_16x16x32_bf16 v[16:19], v[84:87], v[132:135], v[16:19]
s_cmp_eq_u32 s3, 1
s_cbranch_scc0 L_K5
v_mfma_f32_16x16x32_bf16 v[20:23], v[88:91], v[112:115], 0
v_mfma_f32_16x16x32_bf16 v[20:23], v[92:95], v[116:119], v[20:23]
v_mfma_f32_16x16x32_bf16 v[20:23], v[96:99], v[120:123], v[20:23]
v_mfma_f32_16x16x32_bf16 v[20:23], v[100:103], v[124:127], v[20:23]
v_mfma_f32_16x16x32_bf16 v[20:23], v[104:107], v[128:131], v[20:23]
v_mfma_f32_16x16x32_bf16 v[20:23], v[108:111], v[132:135], v[20:23]
s_mov_b32 exec_lo, 0x00ff00ff
s_mov_b32 exec_hi, 0x00ff00ff
v_bfi_b32 v16, v38, s52, v16
v_bfi_b32 v17, v38, s52, v17
v_bfi_b32 v18, v38, s52, v18
v_bfi_b32 v19, v38, s52, v19
buffer_store_dwordx4 v[16:19], v36, s[44:47], 0 offen sc1
s_mov_b32 s33, 393216
s_nop 0
v_bfi_b32 v20, v38, s52, v20
v_bfi_b32 v21, v38, s52, v21
v_bfi_b32 v22, v38, s52, v22
v_bfi_b32 v23, v38, s52, v23
buffer_store_dwordx4 v[20:23], v36, s[44:47], s33 offen sc1
s_branch L_fin
L_K5:
s_mov_b32 exec_lo, 0x00ff00ff
s_mov_b32 exec_hi, 0x00ff00ff
s_nop 3
v_bfi_b32 v16, v38, s52, v16
v_bfi_b32 v17, v38, s52, v17
v_bfi_b32 v18, v38, s52, v18
v_bfi_b32 v19, v38, s52, v19
buffer_store_dwordx4 v[16:19], v36, s[44:47], 0 offen sc1
s_branch L_fin
L_V:
v_lshlrev_b32 v37, 4, v1
s_cmp_eq_u32 s3, 7
s_cbranch_scc1 L_V1
s_mul_i32 s34, s31, 983040
s_mul_i32 s63, s30, 3
s_add_u32 s55, s63, s32
s_lshl_b32 s63, s55, 7
s_add_u32 s34, s34, s63
s_add_u32 s40, s10, s34
s_addc_u32 s41, s11, 0
s_mov_b32 s42, 970880
s_mov_b32 s43, 0x20000
v_lshlrev_b32 v4, 2, v1
v_mul_u32_u24 v7, 20, v5
s_mul_i32 s34, s31, 160
v_mul_u32_u24 v3, 122880, v5
v_lshl_add_u32 v3, v6, 4, v3
buffer_load_dwordx4 v[16:19], v37, s[48:51], 0 offen
buffer_load_dword v20, v4, s[48:51], 0 offen offset:1024
buffer_load_dwordx4 v[24:27], v7, s[48:51], s34 offen
buffer_load_dword v28, v7, s[48:51], s34 offen offset:16
s_mov_b32 s33, 0
buffer_load_dwordx4 v[64:67], v3, s[40:43], s33 offen nt
s_mov_b32 s33, 12288
buffer_load_dwordx4 v[68:71], v3, s[40:43], s33 offen nt
s_mov_b32 s33, 24576
buffer_load_dwordx4 v[72:75], v3, s[40:43], s33 offen nt
s_mov_b32 s33, 36864
buffer_load_dwordx4 v[76:79], v3, s[40:43], s33 offen nt
s_mov_b32 s33, 49152
buffer_load_dwordx4 v[80:83], v3, s[40:43], s33 offen nt
s_mov_b32 s33, 61440
buffer_load_dwordx4 v[84:87], v3, s[40:43], s33 offen nt
s_mov_b32 s33, 73728
buffer_load_dwordx4 v[88:91], v3, s[40:43], s33 offen nt
s_mov_b32 s33, 86016
buffer_load_dwordx4 v[92:95], v3, s[40:43], s33 offen nt
s_mov_b32 s33, 98304
buffer_load_dwordx4 v[96:99], v3, s[40:43], s33 offen nt
s_mov_b32 s33, 110592
buffer_load_dwordx4 v[100:103], v3, s[40:43], s33 offen nt
s_mov_b32 s63, 0xffff
v_and_b32 v7, 1, v1
v_lshlrev_b32 v7, 4, v7
v_lshlrev_b32 v7, v7, s63
v_bfe_u32 v3, v1, 1, 2
v_cmp_eq_u32 vcc, 0, v3
s_nop 1
v_cndmask_b32 v8, 0, v7, vcc
v_cmp_eq_u32 vcc, 1, v3
s_nop 1
v_cndmask_b32 v9, 0, v7, vcc
v_cmp_eq_u32 vcc, 2, v3
s_nop 1
v_cndmask_b32 v10, 0, v7, vcc
v_cmp_eq_u32 vcc, 3, v3
s_nop 1
v_cndmask_b32 v11, 0, v7, vcc
v_lshrrev_b32 v3, 5, v1
v_mul_u32_u24 v4, 768, v3
v_bfe_u32 v3, v1, 4, 1
v_lshl_add_u32 v4, v3, 7, v4
v_lshl_add_u32 v4, v6, 4, v4
s_mul_i32 s34, s32, 1536
v_add_u32 v4, s34, v4
s_lshl_b32 s55, s55, 11
v_add_u32 v32, s55, v37
s_lshl_b32 s34, s31, 8
s_add_u32 s34, s34, s55
v_lshrrev_b32 v3, 4, v1
v_lshl_add_u32 v3, v3, 3, v6
v_lshl_add_u32 v31, v3, 4, s34
v_bfe_u32 v3, v1, 3, 1
v_bfe_u32 v7, v1, 4, 1
v_lshl_add_u32 v3, v3, 1, v7
v_lshrrev_b32 v7, 5, v1
v_lshl_add_u32 v3, v3, 1, v7
v_lshl_add_u32 v3, v3, 3, v6
s_lshl_b32 s34, s32, 7
v_lshl_add_u32 v33, v3, 1, s34
v_mov_b32 v38, 0xff
s_waitcnt vmcnt(12)
v_lshlrev_b32 v104, 16, v16
v_and_b32 v105, 0xffff0000, v16
v_lshlrev_b32 v106, 16, v17
v_and_b32 v107, 0xffff0000, v17
v_lshlrev_b32 v108, 16, v18
v_and_b32 v109, 0xffff0000, v18
v_lshlrev_b32 v110, 16, v19
v_and_b32 v111, 0xffff0000, v19
v_lshlrev_b32 v112, 16, v20
v_and_b32 v113, 0xffff0000, v20
v_readfirstlane_b32 s62, v104
s_nop 1
v_pk_add_f32 v[104:105], v[104:105], s[62:63] op_sel_hi:[1,0] neg_lo:[0,1] neg_hi:[0,1]
v_pk_add_f32 v[106:107], v[106:107], s[62:63] op_sel_hi:[1,0] neg_lo:[0,1] neg_hi:[0,1]
v_pk_add_f32 v[108:109], v[108:109], s[62:63] op_sel_hi:[1,0] neg_lo:[0,1] neg_hi:[0,1]
v_pk_add_f32 v[110:111], v[110:111], s[62:63] op_sel_hi:[1,0] neg_lo:[0,1] neg_hi:[0,1]
v_pk_add_f32 v[112:113], v[112:113], s[62:63] op_sel_hi:[1,0] neg_lo:[0,1] neg_hi:[0,1]
v_pk_mul_f32 v[114:115], v[104:105], v[104:105]
v_pk_fma_f32 v[114:115], v[106:107], v[106:107], v[114:115]
v_pk_add_f32 v[104:105], v[104:105], v[106:107]
v_pk_fma_f32 v[114:115], v[108:109], v[108:109], v[114:115]
v_pk_add_f32 v[104:105], v[104:105], v[108:109]
v_pk_fma_f32 v[114:115], v[110:111], v[110:111], v[114:115]
v_pk_add_f32 v[104:105], v[104:105], v[110:111]
v_pk_fma_f32 v[114:115], v[112:113], v[112:113], v[114:115]
v_pk_add_f32 v[104:105], v[104:105], v[112:113]
v_add_f32 v114, v114, v115
v_add_f32 v104, v104, v105
s_nop 0
s_nop 0
v_add_f32_dpp v114, v114, v114 row_ror:8 row_mask:0xf bank_mask:0xf
v_add_f32_dpp v104, v104, v104 row_ror:8 row_mask:0xf bank_mask:0xf
s_nop 0
v_add_f32_dpp v114, v114, v114 row_ror:4 row_mask:0xf bank_mask:0xf
v_add_f32_dpp v104, v104, v104 row_ror:4 row_mask:0xf bank_mask:0xf
s_nop 0
v_add_f32_dpp v114, v114, v114 row_ror:2 row_mask:0xf bank_mask:0xf
v_add_f32_dpp v104, v104, v104 row_ror:2 row_mask:0xf bank_mask:0xf
s_nop 0
v_add_f32_dpp v114, v114, v114 row_ror:1 row_mask:0xf bank_mask:0xf
v_add_f32_dpp v104, v104, v104 row_ror:1 row_mask:0xf bank_mask:0xf
s_nop 0
v_add_f32_dpp v114, v114, v114 row_bcast:15 row_mask:0xa bank_mask:0xf
v_add_f32_dpp v104, v104, v104 row_bcast:15 row_mask:0xa bank_mask:0xf
s_nop 0
v_add_f32_dpp v114, v114, v114 row_bcast:31 row_mask:0xc bank_mask:0xf
v_add_f32_dpp v104, v104, v104 row_bcast:31 row_mask:0xc bank_mask:0xf
v_mul_f32 v104, 0x3acccccd, v104
v_mul_f32 v114, 0x3acccccd, v114
v_fma_f32 v114, -v104, v104, v114
v_add_f32 v104, s62, v104
v_max_f32 v114, 0, v114
v_readlane_b32 s60, v104, 63
v_readlane_b32 s61, v114, 63
v_mov_b32 v22, 0x3727c5ac
s_waitcnt vmcnt(10)
s_nop 0
v_add_f32 v22, s61, v22
v_rsq_f32 v22, v22
v_lshlrev_b32 v104, 16, v24
v_and_b32 v105, 0xffff0000, v24
v_lshlrev_b32 v106, 16, v25
v_and_b32 v107, 0xffff0000, v25
v_lshlrev_b32 v108, 16, v26
v_and_b32 v109, 0xffff0000, v26
v_lshlrev_b32 v110, 16, v27
v_and_b32 v111, 0xffff0000, v27
v_lshlrev_b32 v112, 16, v28
v_and_b32 v113, 0xffff0000, v28
v_pk_add_f32 v[104:105], v[104:105], s[60:61] op_sel_hi:[1,0] neg_lo:[0,1] neg_hi:[0,1]
v_pk_add_f32 v[106:107], v[106:107], s[60:61] op_sel_hi:[1,0] neg_lo:[0,1] neg_hi:[0,1]
v_pk_add_f32 v[108:109], v[108:109], s[60:61] op_sel_hi:[1,0] neg_lo:[0,1] neg_hi:[0,1]
v_pk_add_f32 v[110:111], v[110:111], s[60:61] op_sel_hi:[1,0] neg_lo:[0,1] neg_hi:[0,1]
v_pk_add_f32 v[112:113], v[112:113], s[60:61] op_sel_hi:[1,0] neg_lo:[0,1] neg_hi:[0,1]
v_pk_mul_f32 v[104:105], v[104:105], v[22:23] op_sel_hi:[1,0]
v_pk_mul_f32 v[106:107], v[106:107], v[22:23] op_sel_hi:[1,0]
v_pk_mul_f32 v[108:109], v[108:109], v[22:23] op_sel_hi:[1,0]
v_pk_mul_f32 v[110:111], v[110:111], v[22:23] op_sel_hi:[1,0]
v_pk_mul_f32 v[112:113], v[112:113], v[22:23] op_sel_hi:[1,0]
v_cvt_pk_bf16_f32 v104, v104, v104
v_cvt_pk_bf16_f32 v105, v105, v105
v_cvt_pk_bf16_f32 v106, v106, v106
v_cvt_pk_bf16_f32 v107, v107, v107
v_cvt_pk_bf16_f32 v108, v108, v108
v_cvt_pk_bf16_f32 v109, v109, v109
v_cvt_pk_bf16_f32 v110, v110, v110
v_cvt_pk_bf16_f32 v111, v111, v111
v_cvt_pk_bf16_f32 v112, v112, v112
v_cvt_pk_bf16_f32 v113, v113, v113
v_and_b32 v116, v8, v104
v_and_b32 v117, v9, v104
v_and_b32 v118, v10, v104
v_and_b32 v119, v11, v104
v_and_b32 v120, v8, v105
v_and_b32 v121, v9, v105
v_and_b32 v122, v10, v105
v_and_b32 v123, v11, v105
v_and_b32 v124, v8, v106
v_and_b32 v125, v9, v106
v_and_b32 v126, v10, v106
v_and_b32 v127, v11, v106
v_and_b32 v128, v8, v107
v_and_b32 v129, v9, v107
v_and_b32 v130, v10, v107
v_and_b32 v131, v11, v107
v_and_b32 v132, v8, v108
v_and_b32 v133, v9, v108
v_and_b32 v134, v10, v108
v_and_b32 v135, v11, v108
v_and_b32 v136, v8, v109
v_and_b32 v137, v9, v109
v_and_b32 v138, v10, v109
v_and_b32 v139, v11, v109
v_and_b32 v140, v8, v110
v_and_b32 v141, v9, v110
v_and_b32 v142, v10, v110
v_and_b32 v143, v11, v110
v_and_b32 v144, v8, v111
v_and_b32 v145, v9, v111
v_and_b32 v146, v10, v111
v_and_b32 v147, v11, v111
v_and_b32 v148, v8, v112
v_and_b32 v149, v9, v112
v_and_b32 v150, v10, v112
v_and_b32 v151, v11, v112
v_and_b32 v152, v8, v113
v_and_b32 v153, v9, v113
v_and_b32 v154, v10, v113
v_and_b32 v155, v11, v113
s_waitcnt lgkmcnt(0)
s_add_u32 s52, s52, 1
s_and_b32 s53, s52, 0xff
s_and_b32 s54, s52, 0xffff
s_waitcnt vmcnt(9)
v_mfma_f32_16x16x32_bf16 v[16:19], v[64:67], v[116:119], 0
s_waitcnt vmcnt(8)
v_mfma_f32_16x16x32_bf16 v[16:19], v[68:71], v[120:123], v[16:19]
s_waitcnt vmcnt(7)
v_mfma_f32_16x16x32_bf16 v[16:19], v[72:75], v[124:127], v[16:19]
s_waitcnt vmcnt(6)
v_mfma_f32_16x16x32_bf16 v[16:19], v[76:79], v[128:131], v[16:19]
s_waitcnt vmcnt(5)
v_mfma_f32_16x16x32_bf16 v[16:19], v[80:83], v[132:135], v[16:19]
s_waitcnt vmcnt(4)
v_mfma_f32_16x16x32_bf16 v[16:19], v[84:87], v[136:139], v[16:19]
s_waitcnt vmcnt(3)
v_mfma_f32_16x16x32_bf16 v[16:19], v[88:91], v[140:143], v[16:19]
s_waitcnt vmcnt(2)
v_mfma_f32_16x16x32_bf16 v[16:19], v[92:95], v[144:147], v[16:19]
s_waitcnt vmcnt(1)
v_mfma_f32_16x16x32_bf16 v[16:19], v[96:99], v[148:151], v[16:19]
s_waitcnt vmcnt(0)
v_mfma_f32_16x16x32_bf16 v[16:19], v[100:103], v[152:155], v[16:19]
s_nop 7
v_mov_b32_dpp v20, v16 row_ror:8 row_mask:0xf bank_mask:0xf
v_mov_b32_dpp v21, v17 row_ror:8 row_mask:0xf bank_mask:0xf
v_mov_b32_dpp v22, v18 row_ror:8 row_mask:0xf bank_mask:0xf
v_mov_b32_dpp v23, v19 row_ror:8 row_mask:0xf bank_mask:0xf
v_permlane32_swap_b32 v20, v24
v_permlane32_swap_b32 v21, v25
v_permlane32_swap_b32 v22, v26
v_permlane32_swap_b32 v23, v27
v_pk_add_f32 v[16:17], v[16:17], v[24:25]
s_nop 0
v_pk_add_f32 v[18:19], v[18:19], v[26:27]
s_mov_b32 exec_lo, 0x00ff00ff
s_mov_b32 exec_hi, 0
v_bfi_b32 v16, v38, s52, v16
v_bfi_b32 v17, v38, s52, v17
v_bfi_b32 v18, v38, s52, v18
v_bfi_b32 v19, v38, s52, v19
buffer_store_dwordx4 v[16:19], v31, s[44:47], 0 offen sc1
s_mov_b64 exec, -1
s_waitcnt vmcnt(0)
s_mov_b32 s34, 32768
L_sp1:
buffer_load_dwordx4 v[64:67], v32, s[44:47], 0 offen sc1
buffer_load_dwordx4 v[68:71], v32, s[44:47], 0 offen offset:1024 sc1
s_sub_u32 s34, s34, 1
s_cbranch_scc1 L_sx1
s_waitcnt vmcnt(0)
v_xor_b32 v64, s53, v64
v_xor_b32 v65, s53, v65
v_xor_b32 v66, s53, v66
v_xor_b32 v67, s53, v67
v_xor_b32 v68, s53, v68
v_xor_b32 v69, s53, v69
v_xor_b32 v70, s53, v70
v_xor_b32 v71, s53, v71
v_or3_b32 v3, v64, v65, v66
v_or3_b32 v3, v3, v67, v68
v_or3_b32 v3, v3, v69, v70
v_or_b32 v3, v3, v71
v_and_b32 v3, 255, v3
v_cmp_ne_u32 vcc, 0, v3
s_cbranch_vccnz L_sp1
L_sx1:
s_waitcnt vmcnt(0)
v_pk_add_f32 v[64:65], v[64:65], v[68:69]
v_pk_add_f32 v[66:67], v[66:67], v[70:71]
s_nop 0
v_permlane32_swap_b32 v64, v65
v_permlane32_swap_b32 v66, v67
s_nop 0
v_add_f32 v64, v64, v65
v_add_f32 v66, v66, v67
s_nop 1
v_permlane16_swap_b32 v64, v66
s_nop 1
v_add_f32 v64, v64, v66
v_cvt_pk_bf16_f32 v64, v64, v64
ds_write_b16 v33, v64 offset:6144
s_lshr_b32 s33, s2, 1
s_lshl_b32 s33, s33, 6
s_and_b32 s34, s2, 1
s_lshl_b32 s34, s34, 3
s_add_u32 s33, s33, s34
v_lshrrev_b32 v3, 1, v6
v_and_b32 v7, 1, v6
v_lshlrev_b32 v7, 2, v7
v_lshl_add_u32 v3, v3, 4, v7
v_add_u32 v3, s33, v3
buffer_load_dword v49, v3, s[48:51], 0 offen
s_waitcnt lgkmcnt(0)
s_branch L_V2
L_V1:
s_cmp_ge_u32 s2, 96
s_cbranch_scc0 L_V3
s_mov_b32 s56, s16
s_mov_b32 s57, s17
s_mov_b32 s58, 3072
s_mov_b32 s59, 0x20000
s_mov_b32 m0, 9216
s_mov_b32 s33, 0
buffer_load_dwordx4 v37, s[56:59], s33 offen lds
s_mov_b32 m0, 10240
s_mov_b32 s33, 1024
buffer_load_dwordx4 v37, s[56:59], s33 offen lds
s_mov_b32 m0, 11264
s_mov_b32 s33, 2048
buffer_load_dwordx4 v37, s[56:59], s33 offen lds
s_mov_b32 s56, s18
s_mov_b32 s57, s19
s_mov_b32 s58, 3072
s_mov_b32 s59, 0x20000
s_mov_b32 m0, 12288
s_mov_b32 s33, 0
buffer_load_dwordx4 v37, s[56:59], s33 offen lds
s_mov_b32 m0, 13312
s_mov_b32 s33, 1024
buffer_load_dwordx4 v37, s[56:59], s33 offen lds
s_mov_b32 m0, 14336
s_mov_b32 s33, 2048
buffer_load_dwordx4 v37, s[56:59], s33 offen lds
s_mov_b32 s56, s20
s_mov_b32 s57, s21
s_mov_b32 s58, 3072
s_mov_b32 s59, 0x20000
s_mov_b32 m0, 15360
s_mov_b32 s33, 0
buffer_load_dwordx4 v37, s[56:59], s33 offen lds
s_mov_b32 m0, 16384
s_mov_b32 s33, 1024
buffer_load_dwordx4 v37, s[56:59], s33 offen lds
s_mov_b32 m0, 17408
s_mov_b32 s33, 2048
buffer_load_dwordx4 v37, s[56:59], s33 offen lds
L_V3:
s_mov_b32 s63, 0xffff
v_and_b32 v7, 1, v1
v_lshlrev_b32 v7, 4, v7
v_lshlrev_b32 v7, v7, s63
v_bfe_u32 v3, v1, 1, 2
v_cmp_eq_u32 vcc, 0, v3
s_nop 1
v_cndmask_b32 v8, 0, v7, vcc
v_cmp_eq_u32 vcc, 1, v3
s_nop 1
v_cndmask_b32 v9, 0, v7, vcc
v_cmp_eq_u32 vcc, 2, v3
s_nop 1
v_cndmask_b32 v10, 0, v7, vcc
v_cmp_eq_u32 vcc, 3, v3
s_nop 1
v_cndmask_b32 v11, 0, v7, vcc
v_lshrrev_b32 v3, 5, v1
v_mul_u32_u24 v4, 768, v3
v_bfe_u32 v3, v1, 4, 1
v_lshl_add_u32 v4, v3, 7, v4
v_lshl_add_u32 v4, v6, 4, v4
s_mul_i32 s34, s32, 1536
v_add_u32 v4, s34, v4
s_waitcnt lgkmcnt(0)
s_add_u32 s52, s52, 1
s_and_b32 s53, s52, 0xff
s_and_b32 s54, s52, 0xffff
L_V2:
s_mov_b32 s56, s22
s_mov_b32 s57, s23
s_mov_b32 s58, 2
s_mov_b32 s59, 0x20000
v_mov_b32 v3, 0
buffer_load_ushort v50, v3, s[56:59], 0 offen
s_barrier
s_mov_b32 s33, 0
buffer_load_dwordx4 v[64:67], v2, s[36:39], s33 offen offset:0 nt
buffer_load_dwordx4 v[68:71], v2, s[36:39], s33 offen offset:128 nt
buffer_load_dwordx4 v[72:75], v2, s[36:39], s33 offen offset:256 nt
s_mov_b32 s33, 3072
buffer_load_dwordx4 v[76:79], v2, s[36:39], s33 offen offset:0 nt
buffer_load_dwordx4 v[80:83], v2, s[36:39], s33 offen offset:128 nt
buffer_load_dwordx4 v[84:87], v2, s[36:39], s33 offen offset:256 nt
s_mov_b32 s33, 6144
buffer_load_dwordx4 v[88:91], v2, s[36:39], s33 offen offset:0 nt
buffer_load_dwordx4 v[92:95], v2, s[36:39], s33 offen offset:128 nt
buffer_load_dwordx4 v[96:99], v2, s[36:39], s33 offen offset:256 nt
s_mov_b32 s33, 9216
buffer_load_dwordx4 v[100:103], v2, s[36:39], s33 offen offset:0 nt
buffer_load_dwordx4 v[104:107], v2, s[36:39], s33 offen offset:128 nt
buffer_load_dwordx4 v[108:111], v2, s[36:39], s33 offen offset:256 nt
s_mov_b32 s33, 12288
buffer_load_dwordx4 v[112:115], v2, s[36:39], s33 offen offset:0 nt
buffer_load_dwordx4 v[116:119], v2, s[36:39], s33 offen offset:128 nt
buffer_load_dwordx4 v[120:123], v2, s[36:39], s33 offen offset:256 nt
s_mov_b32 s33, 15360
buffer_load_dwordx4 v[124:127], v2, s[36:39], s33 offen offset:0 nt
buffer_load_dwordx4 v[128:131], v2, s[36:39], s33 offen offset:128 nt
buffer_load_dwordx4 v[132:135], v2, s[36:39], s33 offen offset:256 nt
s_mov_b32 s33, 18432
buffer_load_dwordx4 v[136:139], v2, s[36:39], s33 offen offset:0 nt
buffer_load_dwordx4 v[140:143], v2, s[36:39], s33 offen offset:128 nt
buffer_load_dwordx4 v[144:147], v2, s[36:39], s33 offen offset:256 nt
s_mov_b32 s33, 21504
buffer_load_dwordx4 v[148:151], v2, s[36:39], s33 offen offset:0 nt
buffer_load_dwordx4 v[152:155], v2, s[36:39], s33 offen offset:128 nt
buffer_load_dwordx4 v[156:159], v2, s[36:39], s33 offen offset:256 nt
s_mov_b32 s33, 24576
buffer_load_dwordx4 v[160:163], v2, s[36:39], s33 offen offset:0 nt
buffer_load_dwordx4 v[164:167], v2, s[36:39], s33 offen offset:128 nt
buffer_load_dwordx4 v[168:171], v2, s[36:39], s33 offen offset:256 nt
s_mov_b32 s33, 27648
buffer_load_dwordx4 v[172:175], v2, s[36:39], s33 offen offset:0 nt
buffer_load_dwordx4 v[176:179], v2, s[36:39], s33 offen offset:128 nt
buffer_load_dwordx4 v[180:183], v2, s[36:39], s33 offen offset:256 nt
s_mov_b32 s33, 30720
buffer_load_dwordx4 v[184:187], v2, s[36:39], s33 offen offset:0 nt
buffer_load_dwordx4 v[188:191], v2, s[36:39], s33 offen offset:128 nt
buffer_load_dwordx4 v[192:195], v2, s[36:39], s33 offen offset:256 nt
s_lshl_b32 s34, s30, 13
s_lshl_b32 s63, s31, 10
s_add_u32 s34, s34, s63
s_add_u32 s34, s34, 262144
v_lshl_add_u32 v51, v1, 4, s34
v_cmp_eq_u32 vcc, 6, v6
v_mov_b32 v52, s53
v_mov_b32 v3, s52
v_mov_b32 v54, 0xff
v_cndmask_b32 v53, v52, v3, vcc
v_cndmask_b32 v52, v52, 0, vcc
v_cndmask_b32 v55, v54, -1, vcc
v_cndmask_b32 v54, v54, 0, vcc
v_not_b32 v56, s52
v_not_b32 v57, s52
v_not_b32 v58, s52
v_not_b32 v59, s52
s_barrier
v_lshlrev_b32 v3, 6, v5
s_lshl_b32 s34, s32, 9
v_add_u32 v3, s34, v3
ds_read_b128 v[28:31], v3 offset:6656
ds_read_b128 v[32:35], v3 offset:6672
ds_read_b128 v[36:39], v3 offset:6688
ds_read_b128 v[40:43], v3 offset:6704
s_mov_b32 s33, 33792
buffer_load_dwordx4 v[196:199], v2, s[36:39], s33 offen offset:0 nt
s_waitcnt lgkmcnt(0)
buffer_load_dwordx4 v[200:203], v2, s[36:39], s33 offen offset:128 nt
v_and_b32 v12, v8, v28
v_and_b32 v13, v9, v28
v_and_b32 v14, v10, v28
v_and_b32 v15, v11, v28
s_waitcnt vmcnt(32)
s_nop 0
v_mfma_f32_16x16x32_bf16 v[16:19], v[64:67], v[12:15], 0
v_mfma_f32_16x16x32_bf16 v[20:23], v[68:71], v[12:15], 0
v_mfma_f32_16x16x32_bf16 v[24:27], v[72:75], v[12:15], 0
buffer_load_dwordx4 v[204:207], v2, s[36:39], s33 offen offset:256 nt
v_and_b32 v44, v8, v29
v_and_b32 v45, v9, v29
v_and_b32 v46, v10, v29
v_and_b32 v47, v11, v29
s_waitcnt vmcnt(30)
s_nop 0
v_mfma_f32_16x16x32_bf16 v[16:19], v[76:79], v[44:47], v[16:19]
v_mfma_f32_16x16x32_bf16 v[20:23], v[80:83], v[44:47], v[20:23]
v_mfma_f32_16x16x32_bf16 v[24:27], v[84:87], v[44:47], v[24:27]
s_mov_b32 s33, 36864
buffer_load_dwordx4 v[208:211], v2, s[36:39], s33 offen offset:0 nt
v_and_b32 v12, v8, v30
v_and_b32 v13, v9, v30
v_and_b32 v14, v10, v30
v_and_b32 v15, v11, v30
s_waitcnt vmcnt(28)
s_nop 0
v_mfma_f32_16x16x32_bf16 v[16:19], v[88:91], v[12:15], v[16:19]
v_mfma_f32_16x16x32_bf16 v[20:23], v[92:95], v[12:15], v[20:23]
v_mfma_f32_16x16x32_bf16 v[24:27], v[96:99], v[12:15], v[24:27]
buffer_load_dwordx4 v[212:215], v2, s[36:39], s33 offen offset:128 nt
v_and_b32 v44, v8, v31
v_and_b32 v45, v9, v31
v_and_b32 v46, v10, v31
v_and_b32 v47, v11, v31
s_waitcnt vmcnt(26)
s_nop 0
v_mfma_f32_16x16x32_bf16 v[16:19], v[100:103], v[44:47], v[16:19]
v_mfma_f32_16x16x32_bf16 v[20:23], v[104:107], v[44:47], v[20:23]
v_mfma_f32_16x16x32_bf16 v[24:27], v[108:111], v[44:47], v[24:27]
buffer_load_dwordx4 v[216:219], v2, s[36:39], s33 offen offset:256 nt
v_and_b32 v12, v8, v32
v_and_b32 v13, v9, v32
v_and_b32 v14, v10, v32
v_and_b32 v15, v11, v32
s_waitcnt vmcnt(24)
s_nop 0
v_mfma_f32_16x16x32_bf16 v[16:19], v[112:115], v[12:15], v[16:19]
v_mfma_f32_16x16x32_bf16 v[20:23], v[116:119], v[12:15], v[20:23]
v_mfma_f32_16x16x32_bf16 v[24:27], v[120:123], v[12:15], v[24:27]
s_mov_b32 s33, 39936
buffer_load_dwordx4 v[220:223], v2, s[36:39], s33 offen offset:0 nt
buffer_load_dwordx4 v[224:227], v2, s[36:39], s33 offen offset:128 nt
buffer_load_dwordx4 v[228:231], v2, s[36:39], s33 offen offset:256 nt
v_and_b32 v44, v8, v33
v_and_b32 v45, v9, v33
v_and_b32 v46, v10, v33
v_and_b32 v47, v11, v33
s_waitcnt vmcnt(24)
s_nop 0
v_mfma_f32_16x16x32_bf16 v[16:19], v[124:127], v[44:47], v[16:19]
v_mfma_f32_16x16x32_bf16 v[20:23], v[128:131], v[44:47], v[20:23]
v_mfma_f32_16x16x32_bf16 v[24:27], v[132:135], v[44:47], v[24:27]
s_mov_b32 s33, 43008
buffer_load_dwordx4 v[232:235], v2, s[36:39], s33 offen offset:0 nt
buffer_load_dwordx4 v[236:239], v2, s[36:39], s33 offen offset:128 nt
buffer_load_dwordx4 v[240:243], v2, s[36:39], s33 offen offset:256 nt
v_and_b32 v12, v8, v34
v_and_b32 v13, v9, v34
v_and_b32 v14, v10, v34
v_and_b32 v15, v11, v34
s_waitcnt vmcnt(24)
s_nop 0
v_mfma_f32_16x16x32_bf16 v[16:19], v[136:139], v[12:15], v[16:19]
v_mfma_f32_16x16x32_bf16 v[20:23], v[140:143], v[12:15], v[20:23]
v_mfma_f32_16x16x32_bf16 v[24:27], v[144:147], v[12:15], v[24:27]
s_mov_b32 s33, 46080
buffer_load_dwordx4 v[244:247], v2, s[36:39], s33 offen offset:0 nt
buffer_load_dwordx4 v[248:251], v2, s[36:39], s33 offen offset:128 nt
buffer_load_dwordx4 v[252:255], v2, s[36:39], s33 offen offset:256 nt
s_barrier
v_and_b32 v44, v8, v35
v_and_b32 v45, v9, v35
v_and_b32 v46, v10, v35
v_and_b32 v47, v11, v35
s_waitcnt vmcnt(24)
s_nop 0
v_mfma_f32_16x16x32_bf16 v[16:19], v[148:151], v[44:47], v[16:19]
v_mfma_f32_16x16x32_bf16 v[20:23], v[152:155], v[44:47], v[20:23]
v_mfma_f32_16x16x32_bf16 v[24:27], v[156:159], v[44:47], v[24:27]
v_and_b32 v12, v8, v36
v_and_b32 v13, v9, v36
v_and_b32 v14, v10, v36
v_and_b32 v15, v11, v36
s_waitcnt vmcnt(21)
s_nop 0
v_mfma_f32_16x16x32_bf16 v[16:19], v[160:163], v[12:15], v[16:19]
v_mfma_f32_16x16x32_bf16 v[20:23], v[164:167], v[12:15], v[20:23]
v_mfma_f32_16x16x32_bf16 v[24:27], v[168:171], v[12:15], v[24:27]
v_and_b32 v44, v8, v37
v_and_b32 v45, v9, v37
v_and_b32 v46, v10, v37
v_and_b32 v47, v11, v37
s_waitcnt vmcnt(18)
s_nop 0
v_mfma_f32_16x16x32_bf16 v[16:19], v[172:175], v[44:47], v[16:19]
v_mfma_f32_16x16x32_bf16 v[20:23], v[176:179], v[44:47], v[20:23]
v_mfma_f32_16x16x32_bf16 v[24:27], v[180:183], v[44:47], v[24:27]
v_and_b32 v12, v8, v38
v_and_b32 v13, v9, v38
v_and_b32 v14, v10, v38
v_and_b32 v15, v11, v38
s_waitcnt vmcnt(15)
s_nop 0
v_mfma_f32_16x16x32_bf16 v[16:19], v[184:187], v[12:15], v[16:19]
v_mfma_f32_16x16x32_bf16 v[20:23], v[188:191], v[12:15], v[20:23]
v_mfma_f32_16x16x32_bf16 v[24:27], v[192:195], v[12:15], v[24:27]
v_and_b32 v44, v8, v39
v_and_b32 v45, v9, v39
v_and_b32 v46, v10, v39
v_and_b32 v47, v11, v39
s_waitcnt vmcnt(12)
s_nop 0
v_mfma_f32_16x16x32_bf16 v[16:19], v[196:199], v[44:47], v[16:19]
v_mfma_f32_16x16x32_bf16 v[20:23], v[200:203], v[44:47], v[20:23]
v_mfma_f32_16x16x32_bf16 v[24:27], v[204:207], v[44:47], v[24:27]
v_and_b32 v12, v8, v40
v_and_b32 v13, v9, v40
v_and_b32 v14, v10, v40
v_and_b32 v15, v11, v40
s_waitcnt vmcnt(9)
s_nop 0
v_mfma_f32_16x16x32_bf16 v[16:19], v[208:211], v[12:15], v[16:19]
v_mfma_f32_16x16x32_bf16 v[20:23], v[212:215], v[12:15], v[20:23]
v_mfma_f32_16x16x32_bf16 v[24:27], v[216:219], v[12:15], v[24:27]
v_and_b32 v44, v8, v41
v_and_b32 v45, v9, v41
v_and_b32 v46, v10, v41
v_and_b32 v47, v11, v41
s_waitcnt vmcnt(6)
s_nop 0
v_mfma_f32_16x16x32_bf16 v[16:19], v[220:223], v[44:47], v[16:19]
v_mfma_f32_16x16x32_bf16 v[20:23], v[224:227], v[44:47], v[20:23]
v_mfma_f32_16x16x32_bf16 v[24:27], v[228:231], v[44:47], v[24:27]
v_and_b32 v12, v8, v42
v_and_b32 v13, v9, v42
v_and_b32 v14, v10, v42
v_and_b32 v15, v11, v42
s_waitcnt vmcnt(3)
s_nop 0
v_mfma_f32_16x16x32_bf16 v[16:19], v[232:235], v[12:15], v[16:19]
v_mfma_f32_16x16x32_bf16 v[20:23], v[236:239], v[12:15], v[20:23]
v_mfma_f32_16x16x32_bf16 v[24:27], v[240:243], v[12:15], v[24:27]
v_and_b32 v44, v8, v43
v_and_b32 v45, v9, v43
v_and_b32 v46, v10, v43
v_and_b32 v47, v11, v43
s_waitcnt vmcnt(0)
s_nop 0
v_mfma_f32_16x16x32_bf16 v[16:19], v[244:247], v[44:47], v[16:19]
v_mfma_f32_16x16x32_bf16 v[20:23], v[248:251], v[44:47], v[20:23]
v_mfma_f32_16x16x32_bf16 v[24:27], v[252:255], v[44:47], v[24:27]
v_lshlrev_b32 v37, 4, v1
s_nop 6
s_mov_b32 exec_lo, 0x00ff00ff
s_mov_b32 exec_hi, 0xff00ff00
ds_write_b128 v4, v[16:19] offset:0
ds_write_b128 v4, v[20:23] offset:256
ds_write_b128 v4, v[24:27] offset:512
s_mov_b64 exec, -1
s_waitcnt lgkmcnt(0)
s_barrier
s_cmp_eq_u32 s3, 7
s_cbranch_scc0 L_V5
s_mov_b32 exec_lo, 0x7f7f7f7f
s_mov_b32 exec_hi, 0x7f7f7f7f
s_mov_b32 s34, 262144
s_mov_b64 s[56:57], exec
s_branch L_pl2
L_pp2:
s_mov_b64 exec, vcc
L_pl2:
buffer_load_dwordx4 v[56:59], v51, s[44:47], 0 offen sc1
s_mov_b64 exec, s[56:57]
s_sub_u32 s34, s34, 1
s_cbranch_scc1 L_px2
s_waitcnt vmcnt(0)
v_xor_b32 v60, v52, v56
v_xor_b32 v61, v52, v57
v_xor_b32 v62, v53, v58
v_xor_b32 v63, v53, v59
v_or_b32 v3, v60, v61
v_or_b32 v7, v62, v63
v_and_b32 v3, v54, v3
v_and_or_b32 v3, v7, v55, v3
v_cmp_ne_u32 vcc, 0, v3
s_cbranch_vccnz L_pp2
L_px2:
ds_write_b128 v37, v[60:63] offset:18432
s_mov_b64 exec, -1
s_waitcnt lgkmcnt(0)
s_barrier
L_V5:
s_cmp_lt_u32 s2, 40
s_cbranch_scc0 L_M
s_lshl_b32 s34, s2, 14
s_lshl_b32 s33, s32, 12
s_add_u32 s34, s34, s33
s_add_u32 s34, s34, 524288
v_add_u32 v30, s34, v37
v_bfe_u32 v3, v1, 4, 1
v_lshrrev_b32 v7, 5, v1
v_lshl_add_u32 v3, v3, 1, v7
v_and_b32 v7, 3, v1
v_lshl_add_u32 v3, v3, 2, v7
s_lshl_b32 s33, s32, 2
v_lshl_add_u32 v31, v3, 4, s33
v_lshlrev_b32 v32, 5, v6
v_lshlrev_b32 v33, 16, v49
v_and_b32 v34, 0xffff0000, v49
v_mul_u32_u24 v48, 4352, v5
v_lshl_add_u32 v48, v6, 3, v48
s_lshl_b32 s33, s2, 6
s_add_u32 s33, s33, 1179648
v_add_u32 v48, s33, v48
v_mov_b32 v38, 0xffff
v_not_b32 v80, s52
v_not_b32 v81, s52
v_not_b32 v82, s52
v_not_b32 v83, s52
v_not_b32 v84, s52
v_not_b32 v85, s52
v_not_b32 v86, s52
v_not_b32 v87, s52
v_not_b32 v88, s52
v_not_b32 v89, s52
v_not_b32 v90, s52
v_not_b32 v91, s52
v_not_b32 v92, s52
v_not_b32 v93, s52
v_not_b32 v94, s52
v_not_b32 v95, s52
s_cmp_eq_u32 s3, 7
s_cbranch_scc1 L_E1
s_barrier
L_E1:
s_mov_b32 s34, 262144
s_mov_b64 s[56:57], exec
s_branch L_pl3
L_pp3:
s_mov_b64 exec, vcc
L_pl3:
buffer_load_dwordx4 v[80:83], v30, s[44:47], 0 offen offset:0 sc1
buffer_load_dwordx4 v[84:87], v30, s[44:47], 0 offen offset:1024 sc1
buffer_load_dwordx4 v[88:91], v30, s[44:47], 0 offen offset:2048 sc1
buffer_load_dwordx4 v[92:95], v30, s[44:47], 0 offen offset:3072 sc1
s_mov_b64 exec, s[56:57]
s_sub_u32 s34, s34, 1
s_cbranch_scc1 L_px3
s_waitcnt vmcnt(0)
v_xor_b32 v64, s53, v80
v_xor_b32 v65, s53, v81
v_xor_b32 v66, s53, v82
v_xor_b32 v67, s53, v83
v_xor_b32 v68, s53, v84
v_xor_b32 v69, s53, v85
v_xor_b32 v70, s53, v86
v_xor_b32 v71, s53, v87
v_xor_b32 v72, s53, v88
v_xor_b32 v73, s53, v89
v_xor_b32 v74, s53, v90
v_xor_b32 v75, s53, v91
v_xor_b32 v76, s53, v92
v_xor_b32 v77, s53, v93
v_xor_b32 v78, s53, v94
v_xor_b32 v79, s53, v95
v_or3_b32 v3, v64, v65, v66
v_or3_b32 v3, v3, v67, v68
v_or3_b32 v3, v3, v69, v70
v_or3_b32 v3, v3, v71, v72
v_or3_b32 v3, v3, v73, v74
v_or3_b32 v3, v3, v75, v76
v_or3_b32 v3, v3, v77, v78
v_or_b32 v3, v3, v79
v_and_b32 v3, 255, v3
v_cmp_ne_u32 vcc, 0, v3
s_cbranch_vccnz L_pp3
L_px3:
v_pk_add_f32 v[64:65], v[64:65], v[72:73]
v_pk_add_f32 v[66:67], v[66:67], v[74:75]
v_pk_add_f32 v[68:69], v[68:69], v[76:77]
v_pk_add_f32 v[70:71], v[70:71], v[78:79]
v_pk_add_f32 v[64:65], v[64:65], v[68:69]
v_pk_add_f32 v[66:67], v[66:67], v[70:71]
s_nop 0
v_permlane32_swap_b32 v64, v65
v_permlane32_swap_b32 v66, v67
s_nop 0
v_add_f32 v64, v64, v65
v_add_f32 v66, v66, v67
s_nop 1
v_permlane16_swap_b32 v64, v66
s_nop 1
v_add_f32 v64, v64, v66
s_nop 1
v_add_f32_dpp v64, v64, v64 row_ror:4 row_mask:0xf bank_mask:0xf
s_nop 1
v_add_f32_dpp v64, v64, v64 row_ror:8 row_mask:0xf bank_mask:0xf
ds_write_b32 v31, v64 offset:8704
s_waitcnt lgkmcnt(0)
s_barrier
s_cmp_eq_u32 s3, 4
s_cbranch_scc0 L_fin
ds_read_b128 v[64:67], v32 offset:8704
ds_read_b128 v[68:71], v32 offset:8720
s_waitcnt lgkmcnt(0)
v_pk_add_f32 v[64:65], v[64:65], v[66:67]
v_pk_add_f32 v[68:69], v[68:69], v[70:71]
v_add_f32 v64, v64, v65
v_add_f32 v68, v68, v69
v_cvt_pk_bf16_f32 v64, v64, v68
v_lshlrev_b32 v65, 16, v64
v_and_b32 v64, 0xffff0000, v64
v_add_f32 v65, v33, v65
v_add_f32 v64, v34, v64
v_cvt_pk_bf16_f32 v64, v65, v64
v_bfi_b32 v65, v38, s52, v64
v_lshl_or_b32 v64, v64, 16, s54
buffer_store_dwordx2 v[64:65], v48, s[44:47], 0 offen sc1
s_branch L_fin
L_M:
s_cmp_ge_u32 s2, 96
s_cbranch_scc0 L_fin
ds_read_b128 v[64:67], v37 offset:9216
ds_read_b128 v[68:71], v37 offset:10240
ds_read_b128 v[72:75], v37 offset:11264
ds_read_b128 v[76:79], v37 offset:12288
ds_read_b128 v[80:83], v37 offset:13312
ds_read_b128 v[84:87], v37 offset:14336
ds_read_b128 v[88:91], v37 offset:15360
ds_read_b128 v[92:95], v37 offset:16384
ds_read_b128 v[96:99], v37 offset:17408
s_mov_b32 s36, s24
s_mov_b32 s37, s25
s_mov_b32 s38, 1280
s_mov_b32 s39, 0x20000
s_sub_u32 s35, s2, 96
s_and_b32 s33, s2, 7
s_mul_i32 s33, s33, 4352
s_add_u32 s33, s33, 1179648
s_lshl_b32 s34, s35, 4
v_mov_b32 v30, s34
v_lshlrev_b32 v31, 3, v1
s_lshr_b32 s34, s35, 3
s_lshl_b32 s34, s34, 5
s_and_b32 s63, s35, 3
s_lshl_b32 s63, s63, 3
s_add_u32 s34, s34, s63
s_and_b32 s63, s35, 4
s_add_u32 s34, s34, s63
s_add_u32 s34, s34, s32
s_lshl_b32 s34, s34, 1
v_mov_b32 v32, s34
s_lshl_b32 s34, s32, 2
v_mov_b32 v33, s34
v_mov_b32 v34, 0
v_lshlrev_b32 v50, 16, v50
s_waitcnt lgkmcnt(0)
v_lshlrev_b32 v128, 16, v64
v_and_b32 v129, 0xffff0000, v64
v_lshlrev_b32 v130, 16, v65
v_and_b32 v131, 0xffff0000, v65
v_lshlrev_b32 v132, 16, v66
v_and_b32 v133, 0xffff0000, v66
v_lshlrev_b32 v134, 16, v67
v_and_b32 v135, 0xffff0000, v67
v_lshlrev_b32 v136, 16, v68
v_and_b32 v137, 0xffff0000, v68
v_lshlrev_b32 v138, 16, v69
v_and_b32 v139, 0xffff0000, v69
v_lshlrev_b32 v140, 16, v70
v_and_b32 v141, 0xffff0000, v70
v_lshlrev_b32 v142, 16, v71
v_and_b32 v143, 0xffff0000, v71
v_lshlrev_b32 v144, 16, v72
v_and_b32 v145, 0xffff0000, v72
v_lshlrev_b32 v146, 16, v73
v_and_b32 v147, 0xffff0000, v73
v_lshlrev_b32 v148, 16, v74
v_and_b32 v149, 0xffff0000, v74
v_lshlrev_b32 v150, 16, v75
v_and_b32 v151, 0xffff0000, v75
v_lshlrev_b32 v152, 16, v76
v_and_b32 v153, 0xffff0000, v76
v_lshlrev_b32 v154, 16, v77
v_and_b32 v155, 0xffff0000, v77
v_lshlrev_b32 v156, 16, v78
v_and_b32 v157, 0xffff0000, v78
v_lshlrev_b32 v158, 16, v79
v_and_b32 v159, 0xffff0000, v79
v_lshlrev_b32 v160, 16, v80
v_and_b32 v161, 0xffff0000, v80
v_lshlrev_b32 v162, 16, v81
v_and_b32 v163, 0xffff0000, v81
v_lshlrev_b32 v164, 16, v82
v_and_b32 v165, 0xffff0000, v82
v_lshlrev_b32 v166, 16, v83
v_and_b32 v167, 0xffff0000, v83
v_lshlrev_b32 v168, 16, v84
v_and_b32 v169, 0xffff0000, v84
v_lshlrev_b32 v170, 16, v85
v_and_b32 v171, 0xffff0000, v85
v_lshlrev_b32 v172, 16, v86
v_and_b32 v173, 0xffff0000, v86
v_lshlrev_b32 v174, 16, v87
v_and_b32 v175, 0xffff0000, v87
v_lshlrev_b32 v176, 16, v88
v_and_b32 v177, 0xffff0000, v88
v_lshlrev_b32 v178, 16, v89
v_and_b32 v179, 0xffff0000, v89
v_lshlrev_b32 v180, 16, v90
v_and_b32 v181, 0xffff0000, v90
v_lshlrev_b32 v182, 16, v91
v_and_b32 v183, 0xffff0000, v91
v_lshlrev_b32 v184, 16, v92
v_and_b32 v185, 0xffff0000, v92
v_lshlrev_b32 v186, 16, v93
v_and_b32 v187, 0xffff0000, v93
v_lshlrev_b32 v188, 16, v94
v_and_b32 v189, 0xffff0000, v94
v_lshlrev_b32 v190, 16, v95
v_and_b32 v191, 0xffff0000, v95
v_lshlrev_b32 v192, 16, v96
v_and_b32 v193, 0xffff0000, v96
v_lshlrev_b32 v194, 16, v97
v_and_b32 v195, 0xffff0000, v97
v_lshlrev_b32 v196, 16, v98
v_and_b32 v197, 0xffff0000, v98
v_lshlrev_b32 v198, 16, v99
v_and_b32 v199, 0xffff0000, v99
v_mov_b32 v36, 0xc0135761
s_mov_b32 s40, 0xbdd2d3e8
v_not_b32 v208, s52
v_not_b32 v209, s52
v_not_b32 v210, s52
v_not_b32 v211, s52
v_not_b32 v212, s52
v_not_b32 v213, s52
v_not_b32 v214, s52
v_not_b32 v215, s52
v_not_b32 v216, s52
v_not_b32 v217, s52
v_not_b32 v218, s52
v_not_b32 v219, s52
v_not_b32 v220, s52
v_not_b32 v221, s52
s_cmp_eq_u32 s3, 7
s_cbranch_scc1 L_E2
s_barrier
L_E2:
s_barrier
s_cmp_eq_u32 s3, 4
s_cbranch_scc0 L_M1
s_mov_b32 s34, 262144
s_mov_b64 s[56:57], exec
s_branch L_pl4
L_pp4:
s_mov_b64 exec, vcc
L_pl4:
buffer_load_dwordx4 v[208:211], v37, s[44:47], s33 offen sc1
buffer_load_dwordx4 v[212:215], v37, s[44:47], s33 offen offset:1024 sc1
buffer_load_dwordx2 v[216:217], v31, s[44:47], s33 offen offset:2048 sc1
buffer_load_dwordx4 v[218:221], v30, s[44:47], s33 offen sc1
s_mov_b64 exec, s[56:57]
s_sub_u32 s34, s34, 1
s_cbranch_scc1 L_px4
s_waitcnt vmcnt(0)
v_xor_b32 v64, s54, v208
v_xor_b32 v65, s54, v209
v_xor_b32 v66, s54, v210
v_xor_b32 v67, s54, v211
v_xor_b32 v68, s54, v212
v_xor_b32 v69, s54, v213
v_xor_b32 v70, s54, v214
v_xor_b32 v71, s54, v215
v_xor_b32 v72, s54, v216
v_xor_b32 v73, s54, v217
v_xor_b32 v40, s54, v218
v_xor_b32 v41, s54, v219
v_xor_b32 v42, s54, v220
v_xor_b32 v43, s54, v221
v_or3_b32 v3, v64, v65, v66
v_or3_b32 v3, v3, v67, v68
v_or3_b32 v3, v3, v69, v70
v_or3_b32 v3, v3, v71, v72
v_or3_b32 v3, v3, v73, v40
v_or3_b32 v3, v3, v41, v42
v_or_b32 v3, v3, v43
v_and_b32 v3, 65535, v3
v_cmp_ne_u32 vcc, 0, v3
s_cbranch_vccnz L_pp4
L_px4:
v_readfirstlane_b32 s62, v64
s_nop 1
v_pk_add_f32 v[64:65], v[64:65], s[62:63] op_sel_hi:[1,0] neg_lo:[0,1] neg_hi:[0,1]
v_pk_add_f32 v[66:67], v[66:67], s[62:63] op_sel_hi:[1,0] neg_lo:[0,1] neg_hi:[0,1]
v_pk_add_f32 v[68:69], v[68:69], s[62:63] op_sel_hi:[1,0] neg_lo:[0,1] neg_hi:[0,1]
v_pk_add_f32 v[70:71], v[70:71], s[62:63] op_sel_hi:[1,0] neg_lo:[0,1] neg_hi:[0,1]
v_pk_add_f32 v[72:73], v[72:73], s[62:63] op_sel_hi:[1,0] neg_lo:[0,1] neg_hi:[0,1]
v_pk_mul_f32 v[74:75], v[64:65], v[64:65]
v_pk_fma_f32 v[74:75], v[66:67], v[66:67], v[74:75]
v_pk_add_f32 v[64:65], v[64:65], v[66:67]
v_pk_fma_f32 v[74:75], v[68:69], v[68:69], v[74:75]
v_pk_add_f32 v[64:65], v[64:65], v[68:69]
v_pk_fma_f32 v[74:75], v[70:71], v[70:71], v[74:75]
v_pk_add_f32 v[64:65], v[64:65], v[70:71]
v_pk_fma_f32 v[74:75], v[72:73], v[72:73], v[74:75]
v_pk_add_f32 v[64:65], v[64:65], v[72:73]
v_add_f32 v74, v74, v75
v_add_f32 v64, v64, v65
s_nop 0
s_nop 0
v_add_f32_dpp v74, v74, v74 row_ror:8 row_mask:0xf bank_mask:0xf
v_add_f32_dpp v64, v64, v64 row_ror:8 row_mask:0xf bank_mask:0xf
s_nop 0
v_add_f32_dpp v74, v74, v74 row_ror:4 row_mask:0xf bank_mask:0xf
v_add_f32_dpp v64, v64, v64 row_ror:4 row_mask:0xf bank_mask:0xf
s_nop 0
v_add_f32_dpp v74, v74, v74 row_ror:2 row_mask:0xf bank_mask:0xf
v_add_f32_dpp v64, v64, v64 row_ror:2 row_mask:0xf bank_mask:0xf
s_nop 0
v_add_f32_dpp v74, v74, v74 row_ror:1 row_mask:0xf bank_mask:0xf
v_add_f32_dpp v64, v64, v64 row_ror:1 row_mask:0xf bank_mask:0xf
s_nop 0
v_add_f32_dpp v74, v74, v74 row_bcast:15 row_mask:0xa bank_mask:0xf
v_add_f32_dpp v64, v64, v64 row_bcast:15 row_mask:0xa bank_mask:0xf
s_nop 0
v_add_f32_dpp v74, v74, v74 row_bcast:31 row_mask:0xc bank_mask:0xf
v_add_f32_dpp v64, v64, v64 row_bcast:31 row_mask:0xc bank_mask:0xf
v_mul_f32 v64, 0x3acccccd, v64
v_mul_f32 v74, 0x3acccccd, v74
v_fma_f32 v74, -v64, v64, v74
v_add_f32 v64, s62, v64
v_max_f32 v74, 0, v74
v_readlane_b32 s60, v64, 63
v_readlane_b32 s61, v74, 63
v_mov_b32 v3, 0x3727c5ac
s_nop 0
v_add_f32 v7, s61, v3
v_rsq_f32 v7, v7
s_nop 0
v_mul_f32 v38, v7, v7
v_fma_f32 v38, v38, s61, v3
v_rsq_f32 v38, v38
s_nop 0
v_mul_f32 v38, v38, v7
v_pk_add_f32 v[44:45], v[40:41], s[60:61] op_sel_hi:[1,0] neg_lo:[0,1] neg_hi:[0,1]
v_pk_add_f32 v[46:47], v[42:43], s[60:61] op_sel_hi:[1,0] neg_lo:[0,1] neg_hi:[0,1]
v_pk_mul_f32 v[44:45], v[44:45], v[38:39] op_sel_hi:[1,0]
v_pk_mul_f32 v[46:47], v[46:47], v[38:39] op_sel_hi:[1,0]
s_mov_b64 exec, 1
ds_write_b128 v34, v[40:43] offset:8976
ds_write_b128 v34, v[44:47] offset:8960
s_mov_b64 exec, -1
s_waitcnt lgkmcnt(0)
L_M1:
s_barrier
ds_read_b32 v38, v33 offset:8960
ds_read_b32 v40, v33 offset:8976
s_waitcnt lgkmcnt(0)
v_pk_fma_f32 v[64:65], v[128:129], v[38:39], v[152:153] op_sel_hi:[1,0,1]
v_pk_fma_f32 v[66:67], v[130:131], v[38:39], v[154:155] op_sel_hi:[1,0,1]
v_pk_fma_f32 v[68:69], v[132:133], v[38:39], v[156:157] op_sel_hi:[1,0,1]
v_pk_fma_f32 v[70:71], v[134:135], v[38:39], v[158:159] op_sel_hi:[1,0,1]
v_pk_mul_f32 v[88:89], v[64:65], v[64:65]
v_pk_mul_f32 v[90:91], v[66:67], v[66:67]
v_pk_mul_f32 v[92:93], v[68:69], v[68:69]
v_pk_mul_f32 v[94:95], v[70:71], v[70:71]
v_pk_fma_f32 v[88:89], v[88:89], s[40:41], v[36:37] op_sel_hi:[1,0,0]
v_pk_fma_f32 v[90:91], v[90:91], s[40:41], v[36:37] op_sel_hi:[1,0,0]
v_pk_fma_f32 v[92:93], v[92:93], s[40:41], v[36:37] op_sel_hi:[1,0,0]
v_pk_fma_f32 v[94:95], v[94:95], s[40:41], v[36:37] op_sel_hi:[1,0,0]
v_pk_mul_f32 v[88:89], v[88:89], v[64:65]
v_pk_mul_f32 v[90:91], v[90:91], v[66:67]
v_pk_mul_f32 v[92:93], v[92:93], v[68:69]
v_pk_mul_f32 v[94:95], v[94:95], v[70:71]
v_exp_f32 v88, v88
v_exp_f32 v89, v89
v_exp_f32 v90, v90
v_exp_f32 v91, v91
v_exp_f32 v92, v92
v_exp_f32 v93, v93
v_exp_f32 v94, v94
v_exp_f32 v95, v95
v_pk_mul_f32 v[64:65], v[64:65], v[176:177]
v_pk_mul_f32 v[66:67], v[66:67], v[178:179]
v_pk_mul_f32 v[68:69], v[68:69], v[180:181]
v_pk_mul_f32 v[70:71], v[70:71], v[182:183]
v_pk_add_f32 v[88:89], v[88:89], 1.0 op_sel_hi:[1,0]
v_pk_add_f32 v[90:91], v[90:91], 1.0 op_sel_hi:[1,0]
v_pk_add_f32 v[92:93], v[92:93], 1.0 op_sel_hi:[1,0]
v_pk_add_f32 v[94:95], v[94:95], 1.0 op_sel_hi:[1,0]
v_rcp_f32 v88, v88
v_rcp_f32 v89, v89
v_rcp_f32 v90, v90
v_rcp_f32 v91, v91
v_rcp_f32 v92, v92
v_rcp_f32 v93, v93
v_rcp_f32 v94, v94
v_rcp_f32 v95, v95
v_pk_mul_f32 v[16:17], v[64:65], v[88:89]
v_pk_mul_f32 v[18:19], v[66:67], v[90:91]
v_pk_fma_f32 v[16:17], v[68:69], v[92:93], v[16:17]
v_pk_fma_f32 v[18:19], v[70:71], v[94:95], v[18:19]
v_pk_fma_f32 v[72:73], v[136:137], v[38:39], v[160:161] op_sel_hi:[1,0,1]
v_pk_fma_f32 v[74:75], v[138:139], v[38:39], v[162:163] op_sel_hi:[1,0,1]
v_pk_fma_f32 v[76:77], v[140:141], v[38:39], v[164:165] op_sel_hi:[1,0,1]
v_pk_fma_f32 v[78:79], v[142:143], v[38:39], v[166:167] op_sel_hi:[1,0,1]
v_pk_mul_f32 v[96:97], v[72:73], v[72:73]
v_pk_mul_f32 v[98:99], v[74:75], v[74:75]
v_pk_mul_f32 v[100:101], v[76:77], v[76:77]
v_pk_mul_f32 v[102:103], v[78:79], v[78:79]
v_pk_fma_f32 v[96:97], v[96:97], s[40:41], v[36:37] op_sel_hi:[1,0,0]
v_pk_fma_f32 v[98:99], v[98:99], s[40:41], v[36:37] op_sel_hi:[1,0,0]
v_pk_fma_f32 v[100:101], v[100:101], s[40:41], v[36:37] op_sel_hi:[1,0,0]
v_pk_fma_f32 v[102:103], v[102:103], s[40:41], v[36:37] op_sel_hi:[1,0,0]
v_pk_mul_f32 v[96:97], v[96:97], v[72:73]
v_pk_mul_f32 v[98:99], v[98:99], v[74:75]
v_pk_mul_f32 v[100:101], v[100:101], v[76:77]
v_pk_mul_f32 v[102:103], v[102:103], v[78:79]
v_exp_f32 v96, v96
v_exp_f32 v97, v97
v_exp_f32 v98, v98
v_exp_f32 v99, v99
v_exp_f32 v100, v100
v_exp_f32 v101, v101
v_exp_f32 v102, v102
v_exp_f32 v103, v103
v_pk_mul_f32 v[72:73], v[72:73], v[184:185]
v_pk_mul_f32 v[74:75], v[74:75], v[186:187]
v_pk_mul_f32 v[76:77], v[76:77], v[188:189]
v_pk_mul_f32 v[78:79], v[78:79], v[190:191]
v_pk_add_f32 v[96:97], v[96:97], 1.0 op_sel_hi:[1,0]
v_pk_add_f32 v[98:99], v[98:99], 1.0 op_sel_hi:[1,0]
v_pk_add_f32 v[100:101], v[100:101], 1.0 op_sel_hi:[1,0]
v_pk_add_f32 v[102:103], v[102:103], 1.0 op_sel_hi:[1,0]
v_rcp_f32 v96, v96
v_rcp_f32 v97, v97
v_rcp_f32 v98, v98
v_rcp_f32 v99, v99
v_rcp_f32 v100, v100
v_rcp_f32 v101, v101
v_rcp_f32 v102, v102
v_rcp_f32 v103, v103
v_pk_fma_f32 v[16:17], v[72:73], v[96:97], v[16:17]
v_pk_fma_f32 v[18:19], v[74:75], v[98:99], v[18:19]
v_pk_fma_f32 v[16:17], v[76:77], v[100:101], v[16:17]
v_pk_fma_f32 v[18:19], v[78:79], v[102:103], v[18:19]
v_pk_fma_f32 v[80:81], v[144:145], v[38:39], v[168:169] op_sel_hi:[1,0,1]
v_pk_fma_f32 v[82:83], v[146:147], v[38:39], v[170:171] op_sel_hi:[1,0,1]
v_pk_fma_f32 v[84:85], v[148:149], v[38:39], v[172:173] op_sel_hi:[1,0,1]
v_pk_fma_f32 v[86:87], v[150:151], v[38:39], v[174:175] op_sel_hi:[1,0,1]
v_pk_mul_f32 v[104:105], v[80:81], v[80:81]
v_pk_mul_f32 v[106:107], v[82:83], v[82:83]
v_pk_mul_f32 v[108:109], v[84:85], v[84:85]
v_pk_mul_f32 v[110:111], v[86:87], v[86:87]
v_pk_fma_f32 v[104:105], v[104:105], s[40:41], v[36:37] op_sel_hi:[1,0,0]
v_pk_fma_f32 v[106:107], v[106:107], s[40:41], v[36:37] op_sel_hi:[1,0,0]
v_pk_fma_f32 v[108:109], v[108:109], s[40:41], v[36:37] op_sel_hi:[1,0,0]
v_pk_fma_f32 v[110:111], v[110:111], s[40:41], v[36:37] op_sel_hi:[1,0,0]
v_pk_mul_f32 v[104:105], v[104:105], v[80:81]
v_pk_mul_f32 v[106:107], v[106:107], v[82:83]
v_pk_mul_f32 v[108:109], v[108:109], v[84:85]
v_pk_mul_f32 v[110:111], v[110:111], v[86:87]
v_exp_f32 v104, v104
v_exp_f32 v105, v105
v_exp_f32 v106, v106
v_exp_f32 v107, v107
v_exp_f32 v108, v108
v_exp_f32 v109, v109
v_exp_f32 v110, v110
v_exp_f32 v111, v111
v_pk_mul_f32 v[80:81], v[80:81], v[192:193]
v_pk_mul_f32 v[82:83], v[82:83], v[194:195]
v_pk_mul_f32 v[84:85], v[84:85], v[196:197]
v_pk_mul_f32 v[86:87], v[86:87], v[198:199]
v_pk_add_f32 v[104:105], v[104:105], 1.0 op_sel_hi:[1,0]
v_pk_add_f32 v[106:107], v[106:107], 1.0 op_sel_hi:[1,0]
v_pk_add_f32 v[108:109], v[108:109], 1.0 op_sel_hi:[1,0]
v_pk_add_f32 v[110:111], v[110:111], 1.0 op_sel_hi:[1,0]
v_rcp_f32 v104, v104
v_rcp_f32 v105, v105
v_rcp_f32 v106, v106
v_rcp_f32 v107, v107
v_rcp_f32 v108, v108
v_rcp_f32 v109, v109
v_rcp_f32 v110, v110
v_rcp_f32 v111, v111
v_pk_fma_f32 v[16:17], v[80:81], v[104:105], v[16:17]
v_pk_fma_f32 v[18:19], v[82:83], v[106:107], v[18:19]
v_pk_fma_f32 v[16:17], v[84:85], v[108:109], v[16:17]
v_pk_fma_f32 v[18:19], v[86:87], v[110:111], v[18:19]
v_pk_add_f32 v[16:17], v[16:17], v[18:19]
v_add_f32 v40, v40, v50
v_add_f32 v16, v16, v17
s_nop 1
v_add_f32_dpp v16, v16, v16 row_ror:8 row_mask:0xf bank_mask:0xf
s_nop 1
v_add_f32_dpp v16, v16, v16 row_ror:4 row_mask:0xf bank_mask:0xf
s_nop 1
v_add_f32_dpp v16, v16, v16 row_ror:2 row_mask:0xf bank_mask:0xf
s_nop 1
v_add_f32_dpp v16, v16, v16 row_ror:1 row_mask:0xf bank_mask:0xf
s_nop 1
v_add_f32_dpp v16, v16, v16 row_bcast:15 row_mask:0xa bank_mask:0xf
s_nop 1
v_add_f32_dpp v16, v16, v16 row_bcast:31 row_mask:0xc bank_mask:0xf
v_add_f32 v16, v16, v40
v_cvt_pk_bf16_f32 v16, v16, v16
s_mov_b32 exec_lo, 0
s_mov_b32 exec_hi, 0x80000000
buffer_store_short v16, v32, s[36:39], 0 offen
s_lshl_b32 s34, s2, 3
s_add_u32 s34, s34, s3
s_cmp_eq_u32 s34, 2047
s_cbranch_scc0 L_fin
v_mov_b32 v3, s52
s_mov_b32 s33, 196608
buffer_store_dword v3, v34, s[44:47], s33 offen
L_fin:
L_end:
s_endpgm
.section .rodata,"a"
.p2align 6
.amdhsa_kernel sequential_preLN__sliding_block_cached__mixer_token_mlp__decode_kernel
  .amdhsa_next_free_vgpr 256
  .amdhsa_next_free_sgpr 102
  .amdhsa_accum_offset 256
  .amdhsa_group_segment_fixed_size 0
  .amdhsa_kernarg_size 104
  .amdhsa_user_sgpr_count 2
  .amdhsa_user_sgpr_kernarg_segment_ptr 1
  .amdhsa_system_sgpr_workgroup_id_x 1
.end_amdhsa_kernel
```
